```python
import torch

def _softmax(x, axis=-1):
    return torch.softmax(x, dim=axis)
def _gelu(x):
    return torch.nn.functional.gelu(x, approximate="tanh")
def _silu(x):
    return torch.nn.functional.silu(x)
def _sigmoid(x):
    return torch.sigmoid(x)
def _layernorm(x, axis=-1, eps=1e-5):
    m = x.mean(dim=axis, keepdim=True)
    v = x.var(dim=axis, keepdim=True, unbiased=False)
    return (x - m) / torch.sqrt(v + eps)
def _scatter_add(tgt, idx, src, axis=0):
    return tgt.clone().index_add_(axis, idx, src)
def _segment_sum(src, seg, n):
    out = torch.zeros((n,) + src.shape[1:], dtype=src.dtype)
    return out.index_add_(0, seg, src)
def _pad(x, pw):
    flat = tuple(v for pair in reversed(pw) for v in pair)
    return torch.nn.functional.pad(x, flat)

kernel_name = 'gated_mix__ssm_conv_s4d__ssm_conv_s4__prompt'

def setup_inputs():

    _w = (lambda a: (lambda t: t.to(torch.bfloat16) if t.is_floating_point() else t)(torch.as_tensor(a)))
    def _A_setup():
        Bsz, L, D, N = 1, 2048, 512, 128
        return {
            "u": _w((lambda *s: torch.randn(*s, dtype=torch.bfloat16) * 0.05)(Bsz, L, D)),
            "log_A_real": _w((lambda *s: torch.randn(*s, dtype=torch.bfloat16) * 3.2)(D, N) * 0.5),
            "A_imag": _w((lambda *s: torch.randn(*s, dtype=torch.bfloat16) * 0.05)(D, N) * 3.14),
            "C_real": _w((lambda *s: torch.randn(*s, dtype=torch.bfloat16) * 0.1)(D, N) / N ** 0.5),
            "C_imag": _w((lambda *s: torch.randn(*s, dtype=torch.bfloat16) * 0.1)(D, N) / N ** 0.5),
            "log_dt": _w((lambda *s: torch.randn(*s, dtype=torch.bfloat16) * 0.05)(D) * 0.5 - 4.0),
            "D_skip": _w((lambda *s: torch.randn(*s, dtype=torch.bfloat16) * 0.05)(D)),
        }
    _A_in = _A_setup()

    def _B_setup():
        B, L, D, N = 1, 2048, 512, 128
        A_re = -(lambda _x: torch.exp(torch.as_tensor(_x)))((lambda *s: torch.randn(*s, dtype=torch.bfloat16) * 3.2)(D, N))
        A_im = torch.pi * (lambda *s: torch.randn(*s, dtype=torch.bfloat16) * 0.05)(D, N)
        B_re = (lambda *s: torch.randn(*s, dtype=torch.bfloat16) * 0.1)(D, N)
        B_im = (lambda *s: torch.randn(*s, dtype=torch.bfloat16) * 0.1)(D, N)
        C_re = (lambda *s: torch.randn(*s, dtype=torch.bfloat16) * 0.1)(D, N)
        C_im = (lambda *s: torch.randn(*s, dtype=torch.bfloat16) * 0.1)(D, N)
        log_dt = (lambda *s: torch.randn(*s, dtype=torch.bfloat16) * 0.05)(D) * 0.5 - 4.0
        Dskip = (lambda *s: torch.randn(*s, dtype=torch.bfloat16) * 0.05)(D)
        return {
            "u": _w((lambda *s: torch.randn(*s, dtype=torch.bfloat16) * 0.05)(B, L, D)),
            "A_re": _w(A_re),
            "A_im": _w(A_im),
            "B_re": _w(B_re),
            "B_im": _w(B_im),
            "C_re": _w(C_re),
            "C_im": _w(C_im),
            "log_dt": _w(log_dt),
            "Dskip": _w(Dskip),
        }
    _B_in = _B_setup()

    return {
        "A_u": _A_in["u"],
        "A_log_A_real": _A_in["log_A_real"],
        "A_A_imag": _A_in["A_imag"],
        "A_C_real": _A_in["C_real"],
        "A_C_imag": _A_in["C_imag"],
        "A_log_dt": _A_in["log_dt"],
        "A_D_skip": _A_in["D_skip"],
        "B_u": _B_in["u"],
        "B_A_re": _B_in["A_re"],
        "B_A_im": _B_in["A_im"],
        "B_B_re": _B_in["B_re"],
        "B_B_im": _B_in["B_im"],
        "B_C_re": _B_in["C_re"],
        "B_C_im": _B_in["C_im"],
        "B_log_dt": _B_in["log_dt"],
        "B_Dskip": _B_in["Dskip"],
        "gate_w": _w((lambda *s: torch.randn(*s, dtype=torch.bfloat16) * 0.05)(512) * 16.0),
    }

def reference(A_u, A_log_A_real, A_A_imag, A_C_real, A_C_imag, A_log_dt, A_D_skip, B_u, B_A_re, B_A_im, B_B_re, B_B_im, B_C_re, B_C_im, B_log_dt, B_Dskip, gate_w):
    def _A_ref(u, log_A_real, A_imag, C_real, C_imag, log_dt, D_skip):
        L = u.shape[1]
        dt = torch.exp(log_dt)
        A = -torch.exp(log_A_real) + 1j * A_imag
        C = (C_real + 1j * C_imag) * dt[:, None]
        pos = (lambda x, dt: x.to(dt))(torch.arange(L), log_dt.dtype)
        P = torch.exp((A * dt[:, None])[:, :, None] * pos[None, None, :])
        K = 2.0 * torch.einsum("dn,dnl->dl", C, P).real
        L2 = 2 * L
        u_t = (lambda x, *d: x.permute(*d))(u, 0, 2, 1)
        Kf = (lambda x, *a, **k: torch.fft.rfft(x.float(), *a, **k))(K, L2)
        Uf = (lambda x, *a, **k: torch.fft.rfft(x.float(), *a, **k))(u_t, L2)
        y = (lambda x, *a, **k: torch.fft.irfft(x, *a, **k).to(torch.bfloat16))(Uf * Kf[None, :, :], L2)[:, :, :L]
        y = (lambda x, *d: x.permute(*d))(y, 0, 2, 1)
        return y + u * D_skip[None, None, :]

    def _B_ref(u, A_re, A_im, B_re, B_im, C_re, C_im, log_dt, Dskip):
        Bsz, L, D = u.shape
        dt = torch.exp(log_dt)[:, None]
        A = A_re + 1j * A_im
        Bc = B_re + 1j * B_im
        Cc = C_re + 1j * C_im
        logdA = dt * A
        dB = dt * Bc
        l = (lambda x, dt: x.to(dt))(torch.arange(L), A_re.dtype)
        P = torch.exp(logdA[:, :, None] * l[None, None, :])
        K = torch.einsum("dn,dnl,dn->dl", Cc, P, dB).real
        L2 = 2 * L
        Kp = _pad(K, ((0, 0), (0, L)))
        up = (lambda x, *d: x.permute(*d))(u, 0, 2, 1)
        up = _pad(up, ((0, 0), (0, 0), (0, L)))
        Kf = (lambda x, axes=(-2,-1): torch.fft.rfft2(x.float(), dim=axes))(Kp[:, None, :], axes=(-2, -1))
        Uf = (lambda x, axes=(-2,-1): torch.fft.rfft2(x.float(), dim=axes))(up[:, :, None, :], axes=(-2, -1))
        Yf = Uf * Kf[None, :, :, :]
        y = (lambda x, s, axes=(-2,-1): torch.fft.irfft2(x, s=s, dim=axes).to(torch.bfloat16))(Yf, (1, L2), axes=(-2, -1))[:, :, 0, :L]
        y = (lambda x, *d: x.permute(*d))(y, 0, 2, 1) + u * Dskip[None, None, :]
        return y

    x = A_u
    g = _sigmoid((x * gate_w).sum(-1, keepdims=True))
    a = _A_ref(x, A_log_A_real, A_A_imag, A_C_real, A_C_imag, A_log_dt, A_D_skip)
    b = _B_ref(x, B_A_re, B_A_im, B_B_re, B_B_im, B_C_re, B_C_im, B_log_dt, B_Dskip)
    return g * a + (1 - g) * b
```

```asm
; @launch grid=(256,1,1) block=(512,1,1) lds=137232
.amdgcn_target "amdgcn-amd-amdhsa--gfx950"
.text
.globl gated_mix__ssm_conv_s4d__ssm_conv_s4__prompt_kernel
.p2align 8
.type gated_mix__ssm_conv_s4d__ssm_conv_s4__prompt_kernel,@function
gated_mix__ssm_conv_s4d__ssm_conv_s4__prompt_kernel:
    s_cmp_ge_u32 s2, 256
    s_cbranch_scc1 L_end
    s_load_dwordx2 s[4:5], s[0:1], 0
    s_load_dwordx4 s[8:11], s[0:1], 136
    s_load_dwordx2 s[12:13], s[0:1], 152
    s_cmp_ge_u32 s2, 256
    s_cbranch_scc1 L_nopf
    s_getpc_b64 s[90:91]
    v_lshlrev_b32 v252, 6, v0
    v_mov_b32 v253, s91
    v_add_co_u32 v252, vcc, s90, v252
    v_addc_co_u32 v253, vcc, 0, v253, vcc
    v_cmp_gt_u32 vcc, 178, v0
    s_and_saveexec_b64 s[92:93], vcc
    s_cbranch_execz L_pfskip
    global_load_dword v254, v[252:253], off
L_pfskip:
    s_mov_b64 exec, s[92:93]
L_nopf:
    v_lshrrev_b32 v1, 6, v0
    v_and_b32 v0, 63, v0
    v_readfirstlane_b32 s3, v1
    s_load_dwordx2 s[42:43], s[0:1], 128
    s_load_dwordx2 s[68:69], s[0:1], 48
    s_load_dwordx2 s[70:71], s[0:1], 120
    s_bfe_u32 s24, s3, 0x10001
    s_cmp_eq_u32 s24, 0
    s_cbranch_scc0 L_ptrB
    s_load_dwordx4 s[28:31], s[0:1], 8
    s_load_dwordx4 s[36:39], s[0:1], 24
    s_load_dwordx2 s[40:41], s[0:1], 40
    s_load_dwordx4 s[32:35], s[0:1], 8
    s_branch L_ptrdone
L_ptrB:
    s_load_dwordx4 s[28:31], s[0:1], 64
    s_load_dwordx4 s[32:35], s[0:1], 80
    s_load_dwordx4 s[36:39], s[0:1], 96
    s_load_dwordx2 s[40:41], s[0:1], 112
L_ptrdone:
    s_and_b32 s20, s2, 7
    s_lshr_b32 s21, s2, 3
    s_lshl_b32 s20, s20, 5
    s_add_u32 s20, s20, s21
    s_lshl_b32 s22, s20, 2
    s_and_b32 s23, s3, 1
    s_lshr_b32 s66, s3, 2
    s_and_b32 s67, s3, 3
    s_lshl_b32 s25, s20, 1
    s_add_u32 s25, s25, s23
    s_lshl_b32 s25, s25, 8
    s_lshl_b32 s26, s66, 7
    s_add_u32 s25, s25, s26
    v_lshlrev_b32 v2, 1, v0
    v_add_u32 v2, s25, v2
    v_mov_b32 v10, 0
    v_mov_b32 v11, 0
    v_mov_b32 v12, 0
    v_mov_b32 v13, 0
    v_mov_b32 v14, 0
    v_mov_b32 v15, 0
    s_lshr_b32 s75, s2, 6
    s_lshr_b32 s27, s3, 2
    s_or_b32 s75, s75, s27
    s_movk_i32 s61, 4096
    s_lshl_b32 s26, s2, 2
    s_add_u32 s26, s26, s3
    s_lshl_b32 s26, s26, 13
    v_lshlrev_b32 v3, 4, v0
    v_add_u32 v4, s26, v3
    s_lshl_b32 s26, s21, 6
    s_lshl_b32 s27, s67, 4
    s_add_u32 s26, s26, s27
    v_and_b32 v1, 15, v0
    v_add_u32 v1, s26, v1
    v_lshlrev_b32 v1, 10, v1
    v_add_u32 v1, s22, v1
    s_waitcnt lgkmcnt(0)
    s_mov_b32 s16, s10
    s_mov_b32 s17, s11
    s_mov_b32 s6, 0x200000
    s_mov_b32 s7, 0x20000
    s_mov_b32 s10, 0x200000
    s_mov_b32 s11, 0x20000
    s_mov_b32 s14, 0x200000
    s_mov_b32 s15, 0x20000
    s_mov_b32 s18, 256
    s_mov_b32 s19, 0x20000
    s_load_dword s44, s[40:41], s22
    s_load_dword s72, s[68:69], s22
    s_load_dword s73, s[70:71], s22
    global_load_short_d16_hi v10, v2, s[28:29]
    global_load_short_d16_hi v11, v2, s[30:31]
    global_load_short_d16_hi v12, v2, s[36:37]
    global_load_short_d16_hi v13, v2, s[38:39]
    global_load_short_d16_hi v14, v2, s[32:33]
    global_load_short_d16_hi v15, v2, s[34:35]
    s_cmp_eq_u32 s75, 0
    s_cbranch_scc0 L_r1
    buffer_load_dwordx4 v[160:163], v4, s[4:7], 0 offen offset:0
    buffer_load_dwordx4 v[164:167], v4, s[4:7], 0 offen offset:1024
    buffer_load_dwordx4 v[168:171], v4, s[4:7], 0 offen offset:2048
    buffer_load_dwordx4 v[172:175], v4, s[4:7], 0 offen offset:3072
    buffer_load_dwordx4 v[176:179], v4, s[4:7], s61 offen offset:0
    buffer_load_dwordx4 v[180:183], v4, s[4:7], s61 offen offset:1024
    buffer_load_dwordx4 v[184:187], v4, s[4:7], s61 offen offset:2048
    buffer_load_dwordx4 v[188:191], v4, s[4:7], s61 offen offset:3072
    global_load_dwordx4 v[24:27], v3, s[42:43]
L_r1:
    s_cmp_lt_u32 s3, 4
    s_cbranch_scc1 L_r2
    buffer_load_dword v1, v1, s[4:7], 0 offen
L_r2:
    s_mul_i32 s45, s67, 4608
    s_add_u32 s45, s45, 69632
    s_mul_i32 s46, s3, 4608
    s_add_u32 s46, s46, 88064
    s_mov_b32 s47, 30041916
    v_mov_b32 v28, 0
    v_mov_b32 v29, 0
    v_mov_b32 v30, 0
    v_mov_b32 v31, 0
    v_and_b32 v5, 31, v0
    v_lshlrev_b32 v5, 4, v5
    v_add_u32 v5, s45, v5
    ds_write_b128 v5, v[28:31] offset:4096
    v_and_b32 v5, 7, v0
    v_lshlrev_b32 v6, 2, v5
    v_lshrrev_b32 v6, v6, s47
    v_and_b32 v6, 15, v6
    v_lshlrev_b32 v6, 4, v6
    v_mul_u32_u24 v5, 4352, v5
    v_add_u32 v5, v5, v6
    v_bfe_u32 v6, v0, 3, 1
    v_mul_u32_u24 v6, 34816, v6
    v_add_u32 v5, v5, v6
    ds_write_b128 v5, v[28:31]
    v_mov_b32 v5, 137216
    ds_write_b32 v5, v28
    v_lshlrev_b32 v6, 2, v0
    v_add_u32 v6, s46, v6
    v_and_b32 v32, 15, v0
    v_lshrrev_b32 v33, 4, v0
    v_mul_u32_u24 v7, 288, v32
    v_lshl_add_u32 v7, v33, 4, v7
    v_add_u32 v7, s46, v7
    v_lshlrev_b32 v8, 11, v0
    v_add_u32 v8, s22, v8
    v_and_b32 v9, 7, v0
    v_lshlrev_b32 v9, 10, v9
    v_add_u32 v9, s22, v9
    v_subrev_u32 v9, 0x2000, v9
    s_lshl_b32 s74, s67, 17
    s_add_u32 s76, s74, 0
    s_add_u32 s77, s74, 524288
    s_add_u32 s78, s74, 1048576
    s_add_u32 s79, s74, 1572864
    s_mov_b64 s[56:57], exec
    s_mov_b32 s58, 0
    s_mov_b32 s59, 0x80000000
    s_mov_b32 s62, -1
    s_mov_b32 s63, 0
    s_waitcnt lgkmcnt(0)
    s_barrier
    s_lshl_b32 s49, s44, 16
    s_and_b32 s50, s44, 0xffff0000
    s_cmp_eq_u32 s23, 0
    s_cselect_b32 s49, s49, s50
    s_mov_b32 s51, 1069066811
    v_mov_b32 v37, s49
    v_mul_f32 v37, s51, v37
    v_exp_f32 v37, v37
    s_nop 0
    v_cvt_pk_bf16_f32 v37, v37, v37
    v_and_b32 v37, 0xffff0000, v37
    s_cmp_eq_u32 s75, 0
    s_cbranch_scc0 L_r3
    s_waitcnt vmcnt(9)
    s_branch L_w1
L_r3:
    s_cmp_lt_u32 s3, 4
    s_cbranch_scc1 L_r4
    s_waitcnt vmcnt(1)
    s_branch L_w1
L_r4:
    s_waitcnt vmcnt(0)
L_w1:
    s_cmp_eq_u32 s24, 0
    s_cbranch_scc0 L_parB
    v_mul_f32 v10, s51, v10
    v_exp_f32 v10, v10
    v_add_f32 v14, v37, v37
    v_mov_b32 v15, 0
    v_cvt_pk_bf16_f32 v10, v10, v10
    v_and_b32 v10, 0xffff0000, v10
    v_xor_b32 v10, 0x80000000, v10
    s_branch L_pardone
L_parB:
    v_mul_f32 v14, v37, v14
    v_mul_f32 v15, v37, v15
L_pardone:
    v_mul_f32 v10, v37, v10
    v_mul_f32 v11, v37, v11
    v_mul_f32 v10, s51, v10
    v_mul_f32 v11, 0.15915494, v11
    v_mul_f32 v34, 0x43000000, v10
    v_mul_f32 v35, 0x43000000, v11
    v_fract_f32 v11, v11
    v_fract_f32 v35, v35
    v_exp_f32 v10, v10
    v_exp_f32 v34, v34
    v_cos_f32 v40, v11
    v_sin_f32 v41, v11
    v_cos_f32 v54, v35
    v_sin_f32 v55, v35
    v_pk_mul_f32 v[84:85], v[12:13], v[14:15] op_sel:[0,0] op_sel_hi:[0,1]
    v_pk_mul_f32 v[40:41], v[40:41], v[10:11] op_sel_hi:[1,0]
    v_pk_mul_f32 v[54:55], v[54:55], v[34:35] op_sel_hi:[1,0]
    v_mov_b32 v255, 0
    v_pk_fma_f32 v[60:61], v[12:13], v[14:15], v[84:85] op_sel:[1,1,0] op_sel_hi:[1,0,1] neg_lo:[0,1,0]
    s_cmp_eq_u32 s75, 0
    s_cbranch_scc0 L_r5
    s_waitcnt vmcnt(0)
    v_dot2_f32_bf16 v192, v160, v24, 0
    v_dot2_f32_bf16 v193, v164, v24, 0
    v_dot2_f32_bf16 v194, v168, v24, 0
    v_dot2_f32_bf16 v195, v172, v24, 0
    v_dot2_f32_bf16 v196, v176, v24, 0
    v_dot2_f32_bf16 v197, v180, v24, 0
    v_dot2_f32_bf16 v198, v184, v24, 0
    v_dot2_f32_bf16 v199, v188, v24, 0
    v_dot2_f32_bf16 v192, v161, v25, v192
    v_dot2_f32_bf16 v193, v165, v25, v193
    v_dot2_f32_bf16 v194, v169, v25, v194
    v_dot2_f32_bf16 v195, v173, v25, v195
    v_dot2_f32_bf16 v196, v177, v25, v196
    v_dot2_f32_bf16 v197, v181, v25, v197
    v_dot2_f32_bf16 v198, v185, v25, v198
    v_dot2_f32_bf16 v199, v189, v25, v199
    v_dot2_f32_bf16 v192, v162, v26, v192
    v_dot2_f32_bf16 v193, v166, v26, v193
    v_dot2_f32_bf16 v194, v170, v26, v194
    v_dot2_f32_bf16 v195, v174, v26, v195
    v_dot2_f32_bf16 v196, v178, v26, v196
    v_dot2_f32_bf16 v197, v182, v26, v197
    v_dot2_f32_bf16 v198, v186, v26, v198
    v_dot2_f32_bf16 v199, v190, v26, v199
    v_dot2_f32_bf16 v192, v163, v27, v192
    v_dot2_f32_bf16 v193, v167, v27, v193
    v_dot2_f32_bf16 v194, v171, v27, v194
    v_dot2_f32_bf16 v195, v175, v27, v195
    v_dot2_f32_bf16 v196, v179, v27, v196
    v_dot2_f32_bf16 v197, v183, v27, v197
    v_dot2_f32_bf16 v198, v187, v27, v198
    v_dot2_f32_bf16 v199, v191, v27, v199
    v_permlane32_swap_b32 v192, v196
    v_permlane32_swap_b32 v193, v197
    v_permlane32_swap_b32 v194, v198
    v_permlane32_swap_b32 v195, v199
    v_add_f32 v192, v192, v196
    v_add_f32 v193, v193, v197
    v_add_f32 v194, v194, v198
    v_add_f32 v195, v195, v199
    s_nop 0
    v_permlane16_swap_b32 v192, v194
    v_permlane16_swap_b32 v193, v195
    v_add_f32 v28, v192, v194
    v_add_f32 v29, v193, v195
    s_nop 0
    v_add_f32_dpp v28, v28, v28 row_shr:1 row_mask:0xf bank_mask:0xf
    v_add_f32_dpp v29, v29, v29 row_shr:1 row_mask:0xf bank_mask:0xf
    s_nop 0
    v_add_f32_dpp v28, v28, v28 row_shr:2 row_mask:0xf bank_mask:0xf
    v_add_f32_dpp v29, v29, v29 row_shr:2 row_mask:0xf bank_mask:0xf
    s_nop 0
    v_add_f32_dpp v28, v28, v28 row_shr:4 row_mask:0xf bank_mask:0xf
    v_add_f32_dpp v29, v29, v29 row_shr:4 row_mask:0xf bank_mask:0xf
    s_nop 0
    v_add_f32_dpp v28, v28, v28 row_shr:8 row_mask:0xf bank_mask:0xf
    v_add_f32_dpp v29, v29, v29 row_shr:8 row_mask:0xf bank_mask:0xf
    v_cvt_pk_bf16_f32 v30, v28, v29
    v_lshlrev_b32 v28, 16, v30
    v_and_b32 v29, 0xffff0000, v30
    v_mul_f32 v28, s51, v28
    v_mul_f32 v29, s51, v29
    v_exp_f32 v28, -v28
    v_exp_f32 v29, -v29
    v_add_f32 v28, 1.0, v28
    v_add_f32 v29, 1.0, v29
    v_rcp_f32 v28, v28
    v_rcp_f32 v29, v29
    s_lshl_b32 s54, s2, 7
    s_lshl_b32 s55, s3, 5
    s_add_u32 s54, s54, s55
    v_lshl_add_u32 v31, v33, 3, s54
    v_cvt_pk_bf16_f32 v30, v28, v29
    v_lshlrev_b32 v28, 16, v30
    v_and_b32 v29, 0xffff0000, v30
    s_mov_b32 exec_lo, 0x80008000
    s_mov_b32 exec_hi, 0x80008000
    buffer_store_dwordx2 v[28:29], v31, s[12:15], 0 offen sc1
    s_mov_b64 exec, s[56:57]
L_r5:
    v_pk_mul_f32 v[84:85], v[40:41], v[40:41] op_sel:[0,0] op_sel_hi:[0,1]
    v_pk_mul_f32 v[86:87], v[54:55], v[54:55] op_sel:[0,0] op_sel_hi:[0,1]
    v_mov_b32 v255, 0
    v_pk_mul_f32 v[88:89], v[60:61], v[54:55] op_sel:[0,0] op_sel_hi:[0,1]
    v_pk_mul_f32 v[90:91], v[60:61], v[40:41] op_sel:[0,0] op_sel_hi:[0,1]
    v_pk_fma_f32 v[42:43], v[40:41], v[40:41], v[84:85] op_sel:[1,1,0] op_sel_hi:[1,0,1] neg_lo:[0,1,0]
    v_pk_fma_f32 v[56:57], v[54:55], v[54:55], v[86:87] op_sel:[1,1,0] op_sel_hi:[1,0,1] neg_lo:[0,1,0]
    v_pk_fma_f32 v[62:63], v[60:61], v[54:55], v[88:89] op_sel:[1,1,0] op_sel_hi:[1,0,1] neg_lo:[0,1,0]
    v_pk_fma_f32 v[76:77], v[60:61], v[40:41], v[90:91] op_sel:[1,1,0] op_sel_hi:[1,0,1] neg_lo:[0,1,0]
    v_cvt_pk_bf16_f32 v92, v60, v61
    ds_write_b32 v6, v92 offset:0
    v_mov_b32 v255, 0
    v_cvt_pk_bf16_f32 v93, v62, v63
    ds_write_b32 v6, v93 offset:2304
    v_cvt_pk_bf16_f32 v94, v76, v77
    ds_write_b32 v6, v94 offset:288
    v_pk_mul_f32 v[84:85], v[42:43], v[42:43] op_sel:[0,0] op_sel_hi:[0,1]
    v_pk_mul_f32 v[86:87], v[56:57], v[56:57] op_sel:[0,0] op_sel_hi:[0,1]
    v_pk_mul_f32 v[88:89], v[62:63], v[40:41] op_sel:[0,0] op_sel_hi:[0,1]
    v_pk_mul_f32 v[90:91], v[60:61], v[56:57] op_sel:[0,0] op_sel_hi:[0,1]
    v_pk_fma_f32 v[44:45], v[42:43], v[42:43], v[84:85] op_sel:[1,1,0] op_sel_hi:[1,0,1] neg_lo:[0,1,0]
    v_pk_fma_f32 v[58:59], v[56:57], v[56:57], v[86:87] op_sel:[1,1,0] op_sel_hi:[1,0,1] neg_lo:[0,1,0]
    v_pk_fma_f32 v[78:79], v[62:63], v[40:41], v[88:89] op_sel:[1,1,0] op_sel_hi:[1,0,1] neg_lo:[0,1,0]
    v_pk_fma_f32 v[64:65], v[60:61], v[56:57], v[90:91] op_sel:[1,1,0] op_sel_hi:[1,0,1] neg_lo:[0,1,0]
    v_mov_b32 v255, 0
    v_mov_b32 v255, 0
    v_cvt_pk_bf16_f32 v95, v78, v79
    ds_write_b32 v6, v95 offset:2592
    v_pk_mul_f32 v[84:85], v[60:61], v[42:43] op_sel:[0,0] op_sel_hi:[0,1]
    v_pk_mul_f32 v[86:87], v[76:77], v[42:43] op_sel:[0,0] op_sel_hi:[0,1]
    v_pk_mul_f32 v[88:89], v[62:63], v[42:43] op_sel:[0,0] op_sel_hi:[0,1]
    v_pk_mul_f32 v[90:91], v[78:79], v[42:43] op_sel:[0,0] op_sel_hi:[0,1]
    v_pk_fma_f32 v[80:81], v[60:61], v[42:43], v[84:85] op_sel:[1,1,0] op_sel_hi:[1,0,1] neg_lo:[0,1,0]
    v_pk_fma_f32 v[76:77], v[76:77], v[42:43], v[86:87] op_sel:[1,1,0] op_sel_hi:[1,0,1] neg_lo:[0,1,0]
    v_pk_fma_f32 v[82:83], v[62:63], v[42:43], v[88:89] op_sel:[1,1,0] op_sel_hi:[1,0,1] neg_lo:[0,1,0]
    v_pk_fma_f32 v[78:79], v[78:79], v[42:43], v[90:91] op_sel:[1,1,0] op_sel_hi:[1,0,1] neg_lo:[0,1,0]
    v_cvt_pk_bf16_f32 v92, v80, v81
    ds_write_b32 v6, v92 offset:576
    v_cvt_pk_bf16_f32 v93, v76, v77
    ds_write_b32 v6, v93 offset:864
    v_cvt_pk_bf16_f32 v94, v82, v83
    ds_write_b32 v6, v94 offset:2880
    v_cvt_pk_bf16_f32 v95, v78, v79
    ds_write_b32 v6, v95 offset:3168
    s_cmp_eq_u32 s75, 0
    s_cbranch_scc0 L_r6
    s_waitcnt vmcnt(0)
    v_mov_b32 v30, 137216
    v_mov_b32 v31, 1
    s_mov_b64 exec, 1
    ds_add_rtn_u32 v29, v30, v31
    s_mov_b64 exec, s[56:57]
L_r6:
    v_pk_mul_f32 v[84:85], v[44:45], v[44:45] op_sel:[0,0] op_sel_hi:[0,1]
    v_pk_mul_f32 v[86:87], v[62:63], v[56:57] op_sel:[0,0] op_sel_hi:[0,1]
    v_pk_mul_f32 v[88:89], v[60:61], v[58:59] op_sel:[0,0] op_sel_hi:[0,1]
    v_pk_mul_f32 v[90:91], v[62:63], v[58:59] op_sel:[0,0] op_sel_hi:[0,1]
    v_pk_fma_f32 v[46:47], v[44:45], v[44:45], v[84:85] op_sel:[1,1,0] op_sel_hi:[1,0,1] neg_lo:[0,1,0]
    v_pk_fma_f32 v[66:67], v[62:63], v[56:57], v[86:87] op_sel:[1,1,0] op_sel_hi:[1,0,1] neg_lo:[0,1,0]
    v_pk_fma_f32 v[68:69], v[60:61], v[58:59], v[88:89] op_sel:[1,1,0] op_sel_hi:[1,0,1] neg_lo:[0,1,0]
    v_pk_fma_f32 v[70:71], v[62:63], v[58:59], v[90:91] op_sel:[1,1,0] op_sel_hi:[1,0,1] neg_lo:[0,1,0]
    v_pk_mul_f32 v[84:85], v[80:81], v[42:43] op_sel:[0,0] op_sel_hi:[0,1]
    v_pk_mul_f32 v[86:87], v[76:77], v[42:43] op_sel:[0,0] op_sel_hi:[0,1]
    v_pk_mul_f32 v[88:89], v[82:83], v[42:43] op_sel:[0,0] op_sel_hi:[0,1]
    v_pk_mul_f32 v[90:91], v[78:79], v[42:43] op_sel:[0,0] op_sel_hi:[0,1]
    v_pk_fma_f32 v[80:81], v[80:81], v[42:43], v[84:85] op_sel:[1,1,0] op_sel_hi:[1,0,1] neg_lo:[0,1,0]
    v_pk_fma_f32 v[76:77], v[76:77], v[42:43], v[86:87] op_sel:[1,1,0] op_sel_hi:[1,0,1] neg_lo:[0,1,0]
    v_pk_fma_f32 v[82:83], v[82:83], v[42:43], v[88:89] op_sel:[1,1,0] op_sel_hi:[1,0,1] neg_lo:[0,1,0]
    v_pk_fma_f32 v[78:79], v[78:79], v[42:43], v[90:91] op_sel:[1,1,0] op_sel_hi:[1,0,1] neg_lo:[0,1,0]
    v_cvt_pk_bf16_f32 v92, v80, v81
    ds_write_b32 v6, v92 offset:1152
    v_cvt_pk_bf16_f32 v93, v76, v77
    ds_write_b32 v6, v93 offset:1440
    v_cvt_pk_bf16_f32 v94, v82, v83
    ds_write_b32 v6, v94 offset:3456
    v_cvt_pk_bf16_f32 v95, v78, v79
    ds_write_b32 v6, v95 offset:3744
    s_cmp_eq_u32 s75, 0
    s_cbranch_scc0 L_r7
    s_waitcnt lgkmcnt(4)
    v_readfirstlane_b32 s60, v29
    s_cmp_eq_u32 s60, 3
    s_cbranch_scc0 L_r7
    s_lshl_b32 s60, s2, 2
    v_mov_b32 v30, s60
    s_mov_b64 exec, 1
    buffer_store_dword v31, v30, s[16:19], 0 offen sc1
    s_mov_b64 exec, s[56:57]
L_r7:
    s_cmp_lt_u32 s3, 4
    s_cbranch_scc1 L_r8
    buffer_load_dword v17, v8, s[4:7], s76 offen
L_r8:
    v_pk_mul_f32 v[84:85], v[46:47], v[46:47] op_sel:[0,0] op_sel_hi:[0,1]
    v_pk_mul_f32 v[86:87], v[64:65], v[58:59] op_sel:[0,0] op_sel_hi:[0,1]
    v_pk_mul_f32 v[88:89], v[66:67], v[58:59] op_sel:[0,0] op_sel_hi:[0,1]
    v_mov_b32 v255, 0
    v_pk_fma_f32 v[48:49], v[46:47], v[46:47], v[84:85] op_sel:[1,1,0] op_sel_hi:[1,0,1] neg_lo:[0,1,0]
    v_pk_fma_f32 v[72:73], v[64:65], v[58:59], v[86:87] op_sel:[1,1,0] op_sel_hi:[1,0,1] neg_lo:[0,1,0]
    v_pk_fma_f32 v[74:75], v[66:67], v[58:59], v[88:89] op_sel:[1,1,0] op_sel_hi:[1,0,1] neg_lo:[0,1,0]
    v_pk_mul_f32 v[84:85], v[80:81], v[42:43] op_sel:[0,0] op_sel_hi:[0,1]
    v_pk_mul_f32 v[86:87], v[76:77], v[42:43] op_sel:[0,0] op_sel_hi:[0,1]
    v_pk_mul_f32 v[88:89], v[82:83], v[42:43] op_sel:[0,0] op_sel_hi:[0,1]
    v_pk_mul_f32 v[90:91], v[78:79], v[42:43] op_sel:[0,0] op_sel_hi:[0,1]
    v_pk_fma_f32 v[80:81], v[80:81], v[42:43], v[84:85] op_sel:[1,1,0] op_sel_hi:[1,0,1] neg_lo:[0,1,0]
    v_pk_fma_f32 v[76:77], v[76:77], v[42:43], v[86:87] op_sel:[1,1,0] op_sel_hi:[1,0,1] neg_lo:[0,1,0]
    v_pk_fma_f32 v[82:83], v[82:83], v[42:43], v[88:89] op_sel:[1,1,0] op_sel_hi:[1,0,1] neg_lo:[0,1,0]
    v_pk_fma_f32 v[78:79], v[78:79], v[42:43], v[90:91] op_sel:[1,1,0] op_sel_hi:[1,0,1] neg_lo:[0,1,0]
    v_cvt_pk_bf16_f32 v92, v80, v81
    ds_write_b32 v6, v92 offset:1728
    v_cvt_pk_bf16_f32 v93, v76, v77
    ds_write_b32 v6, v93 offset:2016
    v_cvt_pk_bf16_f32 v94, v82, v83
    ds_write_b32 v6, v94 offset:4032
    v_cvt_pk_bf16_f32 v95, v78, v79
    ds_write_b32 v6, v95 offset:4320
    ds_read_b128 v[112:115], v7 offset:0
    ds_read_b128 v[116:119], v7 offset:64
    ds_read_b128 v[120:123], v7 offset:128
    ds_read_b128 v[124:127], v7 offset:192
    v_mov_b32 v36, 0x3f80
    ds_write_b32 v6, v36
    v_pk_mul_f32 v[84:85], v[48:49], v[46:47] op_sel:[0,0] op_sel_hi:[0,1]
    v_pk_mul_f32 v[86:87], v[48:49], v[48:49] op_sel:[0,0] op_sel_hi:[0,1]
    v_cvt_pk_bf16_f32 v92, v46, -v47
    ds_write_b32 v6, v92 offset:288
    v_mov_b32 v255, 0
    v_pk_fma_f32 v[50:51], v[48:49], v[46:47], v[84:85] op_sel:[1,1,0] op_sel_hi:[1,0,1] neg_lo:[0,1,0]
    v_pk_fma_f32 v[52:53], v[48:49], v[48:49], v[86:87] op_sel:[1,1,0] op_sel_hi:[1,0,1] neg_lo:[0,1,0]
    v_cvt_pk_bf16_f32 v93, v48, -v49
    ds_write_b32 v6, v93 offset:576
    v_mov_b32 v255, 0
    v_cvt_pk_bf16_f32 v94, v50, -v51
    ds_write_b32 v6, v94 offset:864
    v_cvt_pk_bf16_f32 v95, v52, -v53
    ds_write_b32 v6, v95 offset:1152
    s_cmp_lt_u32 s3, 4
    s_cbranch_scc1 L_r9
    v_add_u32 v4, s76, v9
    buffer_load_dword v18, v8, s[4:7], s76 offen offset:1024
    s_mov_b64 exec, 0xff
    buffer_load_dword v16, v4, s[4:7], 0 offen
    s_mov_b64 exec, s[56:57]
L_r9:
    v_pk_mul_f32 v[84:85], v[46:47], v[52:53] op_sel:[0,0] op_sel_hi:[0,1]
    v_pk_mul_f32 v[86:87], v[48:49], v[52:53] op_sel:[0,0] op_sel_hi:[0,1]
    v_pk_mul_f32 v[88:89], v[50:51], v[52:53] op_sel:[0,0] op_sel_hi:[0,1]
    v_pk_mul_f32 v[90:91], v[52:53], v[52:53] op_sel:[0,0] op_sel_hi:[0,1]
    v_pk_fma_f32 v[78:79], v[46:47], v[52:53], v[84:85] op_sel:[1,1,0] op_sel_hi:[1,0,1] neg_lo:[0,1,0]
    v_pk_fma_f32 v[80:81], v[48:49], v[52:53], v[86:87] op_sel:[1,1,0] op_sel_hi:[1,0,1] neg_lo:[0,1,0]
    v_pk_fma_f32 v[82:83], v[50:51], v[52:53], v[88:89] op_sel:[1,1,0] op_sel_hi:[1,0,1] neg_lo:[0,1,0]
    v_pk_fma_f32 v[76:77], v[52:53], v[52:53], v[90:91] op_sel:[1,1,0] op_sel_hi:[1,0,1] neg_lo:[0,1,0]
    v_cvt_pk_bf16_f32 v92, v78, -v79
    ds_write_b32 v6, v92 offset:1440
    v_cvt_pk_bf16_f32 v93, v80, -v81
    ds_write_b32 v6, v93 offset:1728
    v_cvt_pk_bf16_f32 v94, v82, -v83
    ds_write_b32 v6, v94 offset:2016
    v_cvt_pk_bf16_f32 v95, v76, -v77
    ds_write_b32 v6, v95 offset:2304
    v_pk_mul_f32 v[84:85], v[78:79], v[52:53] op_sel:[0,0] op_sel_hi:[0,1]
    v_pk_mul_f32 v[86:87], v[80:81], v[52:53] op_sel:[0,0] op_sel_hi:[0,1]
    v_pk_mul_f32 v[88:89], v[82:83], v[52:53] op_sel:[0,0] op_sel_hi:[0,1]
    v_pk_mul_f32 v[90:91], v[76:77], v[52:53] op_sel:[0,0] op_sel_hi:[0,1]
    v_pk_fma_f32 v[78:79], v[78:79], v[52:53], v[84:85] op_sel:[1,1,0] op_sel_hi:[1,0,1] neg_lo:[0,1,0]
    v_pk_fma_f32 v[80:81], v[80:81], v[52:53], v[86:87] op_sel:[1,1,0] op_sel_hi:[1,0,1] neg_lo:[0,1,0]
    v_pk_fma_f32 v[82:83], v[82:83], v[52:53], v[88:89] op_sel:[1,1,0] op_sel_hi:[1,0,1] neg_lo:[0,1,0]
    v_pk_fma_f32 v[76:77], v[76:77], v[52:53], v[90:91] op_sel:[1,1,0] op_sel_hi:[1,0,1] neg_lo:[0,1,0]
    v_cvt_pk_bf16_f32 v92, v78, -v79
    ds_write_b32 v6, v92 offset:2592
    v_cvt_pk_bf16_f32 v93, v80, -v81
    ds_write_b32 v6, v93 offset:2880
    v_cvt_pk_bf16_f32 v94, v82, -v83
    ds_write_b32 v6, v94 offset:3168
    v_cvt_pk_bf16_f32 v95, v76, -v77
    ds_write_b32 v6, v95 offset:3456
    v_pk_mul_f32 v[84:85], v[78:79], v[52:53] op_sel:[0,0] op_sel_hi:[0,1]
    v_pk_mul_f32 v[86:87], v[80:81], v[52:53] op_sel:[0,0] op_sel_hi:[0,1]
    v_pk_mul_f32 v[88:89], v[82:83], v[52:53] op_sel:[0,0] op_sel_hi:[0,1]
    v_mov_b32 v255, 0
    v_pk_fma_f32 v[78:79], v[78:79], v[52:53], v[84:85] op_sel:[1,1,0] op_sel_hi:[1,0,1] neg_lo:[0,1,0]
    v_pk_fma_f32 v[80:81], v[80:81], v[52:53], v[86:87] op_sel:[1,1,0] op_sel_hi:[1,0,1] neg_lo:[0,1,0]
    v_pk_fma_f32 v[82:83], v[82:83], v[52:53], v[88:89] op_sel:[1,1,0] op_sel_hi:[1,0,1] neg_lo:[0,1,0]
    v_mov_b32 v255, 0
    v_cvt_pk_bf16_f32 v92, v78, -v79
    ds_write_b32 v6, v92 offset:3744
    v_cvt_pk_bf16_f32 v93, v80, -v81
    ds_write_b32 v6, v93 offset:4032
    v_cvt_pk_bf16_f32 v94, v82, -v83
    ds_write_b32 v6, v94 offset:4320
    ds_read_b128 v[96:99], v7 offset:0
    ds_read_b128 v[100:103], v7 offset:64
    ds_read_b128 v[104:107], v7 offset:128
    ds_read_b128 v[108:111], v7 offset:192
    s_cmp_lt_u32 s3, 4
    s_cbranch_scc1 L_r10
    buffer_load_dword v20, v8, s[4:7], s77 offen
L_r10:
    v_pk_mul_f32 v[84:85], v[64:65], v[42:43] op_sel:[0,0] op_sel_hi:[0,1]
    v_pk_mul_f32 v[86:87], v[66:67], v[42:43] op_sel:[0,0] op_sel_hi:[0,1]
    v_pk_mul_f32 v[88:89], v[64:65], v[44:45] op_sel:[0,0] op_sel_hi:[0,1]
    v_pk_mul_f32 v[90:91], v[66:67], v[44:45] op_sel:[0,0] op_sel_hi:[0,1]
    v_cvt_pk_bf16_f32 v95, v64, v65
    ds_write_b32 v6, v95 offset:0
    v_pk_fma_f32 v[76:77], v[64:65], v[42:43], v[84:85] op_sel:[1,1,0] op_sel_hi:[1,0,1] neg_lo:[0,1,0]
    v_pk_fma_f32 v[78:79], v[66:67], v[42:43], v[86:87] op_sel:[1,1,0] op_sel_hi:[1,0,1] neg_lo:[0,1,0]
    v_pk_fma_f32 v[80:81], v[64:65], v[44:45], v[88:89] op_sel:[1,1,0] op_sel_hi:[1,0,1] neg_lo:[0,1,0]
    v_pk_fma_f32 v[82:83], v[66:67], v[44:45], v[90:91] op_sel:[1,1,0] op_sel_hi:[1,0,1] neg_lo:[0,1,0]
    v_cvt_pk_bf16_f32 v92, v66, v67
    ds_write_b32 v6, v92 offset:1152
    v_cvt_pk_bf16_f32 v93, v76, v77
    ds_write_b32 v6, v93 offset:288
    v_cvt_pk_bf16_f32 v94, v78, v79
    ds_write_b32 v6, v94 offset:1440
    v_cvt_pk_bf16_f32 v95, v80, v81
    ds_write_b32 v6, v95 offset:576
    v_cvt_pk_bf16_f32 v92, v82, v83
    ds_write_b32 v6, v92 offset:1728
    v_pk_mul_f32 v[84:85], v[80:81], v[42:43] op_sel:[0,0] op_sel_hi:[0,1]
    v_pk_mul_f32 v[86:87], v[82:83], v[42:43] op_sel:[0,0] op_sel_hi:[0,1]
    v_pk_mul_f32 v[88:89], v[68:69], v[44:45] op_sel:[0,0] op_sel_hi:[0,1]
    v_pk_mul_f32 v[90:91], v[70:71], v[44:45] op_sel:[0,0] op_sel_hi:[0,1]
    v_cvt_pk_bf16_f32 v93, v68, v69
    ds_write_b32 v6, v93 offset:2304
    s_waitcnt lgkmcnt(7)
    v_mfma_f32_16x16x32_bf16 v[128:131], v[112:115], v[96:99], 0
    v_pk_fma_f32 v[80:81], v[80:81], v[42:43], v[84:85] op_sel:[1,1,0] op_sel_hi:[1,0,1] neg_lo:[0,1,0]
    v_pk_fma_f32 v[82:83], v[82:83], v[42:43], v[86:87] op_sel:[1,1,0] op_sel_hi:[1,0,1] neg_lo:[0,1,0]
    v_pk_fma_f32 v[76:77], v[68:69], v[44:45], v[88:89] op_sel:[1,1,0] op_sel_hi:[1,0,1] neg_lo:[0,1,0]
    v_pk_fma_f32 v[78:79], v[70:71], v[44:45], v[90:91] op_sel:[1,1,0] op_sel_hi:[1,0,1] neg_lo:[0,1,0]
    v_cvt_pk_bf16_f32 v94, v70, v71
    ds_write_b32 v6, v94 offset:2880
    v_mfma_f32_16x16x32_bf16 v[128:131], v[116:119], v[100:103], v[128:131]
    v_cvt_pk_bf16_f32 v95, v80, v81
    ds_write_b32 v6, v95 offset:864
    v_cvt_pk_bf16_f32 v92, v82, v83
    ds_write_b32 v6, v92 offset:2016
    v_cvt_pk_bf16_f32 v93, v76, v77
    ds_write_b32 v6, v93 offset:2592
    v_cvt_pk_bf16_f32 v94, v78, v79
    ds_write_b32 v6, v94 offset:3168
    v_pk_mul_f32 v[84:85], v[72:73], v[44:45] op_sel:[0,0] op_sel_hi:[0,1]
    v_pk_mul_f32 v[86:87], v[74:75], v[44:45] op_sel:[0,0] op_sel_hi:[0,1]
    v_pk_mul_f32 v[88:89], v[68:69], v[58:59] op_sel:[0,0] op_sel_hi:[0,1]
    v_pk_mul_f32 v[90:91], v[70:71], v[58:59] op_sel:[0,0] op_sel_hi:[0,1]
    v_cvt_pk_bf16_f32 v95, v72, v73
    ds_write_b32 v6, v95 offset:3456
    v_mfma_f32_16x16x32_bf16 v[128:131], v[120:123], v[104:107], v[128:131]
    v_pk_fma_f32 v[76:77], v[72:73], v[44:45], v[84:85] op_sel:[1,1,0] op_sel_hi:[1,0,1] neg_lo:[0,1,0]
    v_pk_fma_f32 v[78:79], v[74:75], v[44:45], v[86:87] op_sel:[1,1,0] op_sel_hi:[1,0,1] neg_lo:[0,1,0]
    v_pk_fma_f32 v[68:69], v[68:69], v[58:59], v[88:89] op_sel:[1,1,0] op_sel_hi:[1,0,1] neg_lo:[0,1,0]
    v_pk_fma_f32 v[70:71], v[70:71], v[58:59], v[90:91] op_sel:[1,1,0] op_sel_hi:[1,0,1] neg_lo:[0,1,0]
    v_cvt_pk_bf16_f32 v92, v74, v75
    ds_write_b32 v6, v92 offset:4032
    v_mfma_f32_16x16x32_bf16 v[128:131], v[124:127], v[108:111], v[128:131]
    v_cvt_pk_bf16_f32 v93, v76, v77
    ds_write_b32 v6, v93 offset:3744
    v_cvt_pk_bf16_f32 v94, v78, v79
    ds_write_b32 v6, v94 offset:4320
    ds_read_b128 v[140:143], v7 offset:0
    ds_read_b128 v[144:147], v7 offset:64
    ds_read_b128 v[148:151], v7 offset:128
    ds_read_b128 v[152:155], v7 offset:192
    s_cmp_lt_u32 s3, 4
    s_cbranch_scc1 L_r11
    v_add_u32 v4, s77, v9
    buffer_load_dword v21, v8, s[4:7], s77 offen offset:1024
    s_mov_b64 exec, 0xff
    buffer_load_dword v19, v4, s[4:7], 0 offen
    s_mov_b64 exec, s[56:57]
L_r11:
    v_pk_mul_f32 v[84:85], v[72:73], v[58:59] op_sel:[0,0] op_sel_hi:[0,1]
    v_pk_mul_f32 v[86:87], v[74:75], v[58:59] op_sel:[0,0] op_sel_hi:[0,1]
    v_pk_mul_f32 v[88:89], v[68:69], v[58:59] op_sel:[0,0] op_sel_hi:[0,1]
    v_pk_mul_f32 v[90:91], v[70:71], v[58:59] op_sel:[0,0] op_sel_hi:[0,1]
    v_cvt_pk_bf16_f32 v95, v68, v69
    ds_write_b32 v6, v95 offset:0
    v_pk_fma_f32 v[72:73], v[72:73], v[58:59], v[84:85] op_sel:[1,1,0] op_sel_hi:[1,0,1] neg_lo:[0,1,0]
    v_pk_fma_f32 v[74:75], v[74:75], v[58:59], v[86:87] op_sel:[1,1,0] op_sel_hi:[1,0,1] neg_lo:[0,1,0]
    v_pk_fma_f32 v[76:77], v[68:69], v[58:59], v[88:89] op_sel:[1,1,0] op_sel_hi:[1,0,1] neg_lo:[0,1,0]
    v_pk_fma_f32 v[78:79], v[70:71], v[58:59], v[90:91] op_sel:[1,1,0] op_sel_hi:[1,0,1] neg_lo:[0,1,0]
    v_cvt_pk_bf16_f32 v92, v70, v71
    ds_write_b32 v6, v92 offset:288
    v_cvt_pk_bf16_f32 v93, v72, v73
    ds_write_b32 v6, v93 offset:576
    v_cvt_pk_bf16_f32 v94, v74, v75
    ds_write_b32 v6, v94 offset:864
    v_cvt_pk_bf16_f32 v95, v76, v77
    ds_write_b32 v6, v95 offset:1152
    v_cvt_pk_bf16_f32 v92, v78, v79
    ds_write_b32 v6, v92 offset:1440
    v_pk_mul_f32 v[84:85], v[72:73], v[58:59] op_sel:[0,0] op_sel_hi:[0,1]
    v_pk_mul_f32 v[86:87], v[74:75], v[58:59] op_sel:[0,0] op_sel_hi:[0,1]
    v_pk_mul_f32 v[88:89], v[76:77], v[58:59] op_sel:[0,0] op_sel_hi:[0,1]
    s_waitcnt lgkmcnt(6)
    v_mfma_f32_16x16x32_bf16 v[132:135], v[140:143], v[96:99], 0
    v_mov_b32 v255, 0
    v_pk_fma_f32 v[72:73], v[72:73], v[58:59], v[84:85] op_sel:[1,1,0] op_sel_hi:[1,0,1] neg_lo:[0,1,0]
    v_pk_fma_f32 v[74:75], v[74:75], v[58:59], v[86:87] op_sel:[1,1,0] op_sel_hi:[1,0,1] neg_lo:[0,1,0]
    v_pk_fma_f32 v[76:77], v[76:77], v[58:59], v[88:89] op_sel:[1,1,0] op_sel_hi:[1,0,1] neg_lo:[0,1,0]
    v_mfma_f32_16x16x32_bf16 v[132:135], v[144:147], v[100:103], v[132:135]
    v_mov_b32 v255, 0
    v_cvt_pk_bf16_f32 v93, v72, v73
    ds_write_b32 v6, v93 offset:1728
    v_cvt_pk_bf16_f32 v94, v74, v75
    ds_write_b32 v6, v94 offset:2016
    v_cvt_pk_bf16_f32 v95, v76, v77
    ds_write_b32 v6, v95 offset:2304
    ds_read_b128 v[112:115], v7 offset:0
    ds_read_b128 v[116:119], v7 offset:64
    ds_read_b128 v[120:123], v7 offset:128
    ds_read_b128 v[124:127], v7 offset:192
    v_mfma_f32_16x16x32_bf16 v[132:135], v[148:151], v[104:107], v[132:135]
    v_mfma_f32_16x16x32_bf16 v[132:135], v[152:155], v[108:111], v[132:135]
    s_mul_i32 s48, s67, 3072
    s_add_u32 s48, s48, 124928
    v_lshlrev_b32 v34, 4, v0
    v_add_u32 v34, s48, v34
    s_waitcnt lgkmcnt(0)
    v_mfma_f32_16x16x32_bf16 v[136:139], v[112:115], v[96:99], 0
    v_mfma_f32_16x16x32_bf16 v[136:139], v[116:119], v[100:103], v[136:139]
    v_mfma_f32_16x16x32_bf16 v[136:139], v[120:123], v[104:107], v[136:139]
    v_mfma_f32_16x16x32_bf16 v[136:139], v[124:127], v[108:111], v[136:139]
    s_cmp_lt_u32 s3, 4
    s_cbranch_scc0 L_helper
    v_lshlrev_b32 v8, 1, v32
    v_sub_u32 v8, v33, v8
    v_add_u32 v8, 30, v8
    v_lshlrev_b32 v8, 4, v8
    v_add_u32 v8, s45, v8
    v_add_u32 v38, 1, v32
    v_and_b32 v35, 7, v38
    v_lshrrev_b32 v38, 3, v38
    v_add_u32 v38, v38, v33
    v_lshlrev_b32 v36, 2, v35
    v_lshrrev_b32 v36, v36, s47
    v_and_b32 v36, 15, v36
    v_add_u32 v38, v38, v36
    v_lshlrev_b32 v38, 4, v38
    v_mul_u32_u24 v9, 4352, v35
    v_add_u32 v9, v9, v38
    s_mul_i32 s48, s23, 34816
    v_add_u32 v9, s48, v9
    v_lshrrev_b32 v40, 1, v33
    v_lshl_add_u32 v40, v40, 4, v32
    v_sub_u32 v40, 255, v40
    v_lshlrev_b32 v40, 4, v40
    v_and_b32 v41, 1, v33
    v_xor_b32 v41, 1, v41
    v_lshl_add_u32 v40, v41, 3, v40
    v_add_u32 v40, s45, v40
    v_lshl_add_u32 v44, v33, 4, v32
    v_add_u32 v44, 32, v44
    v_lshl_add_u32 v45, v33, 5, v32
    v_cndmask_b32 v44, v45, v44, s[62:63]
    v_lshlrev_b32 v45, 2, v44
    v_add_u32 v45, s46, v45
    v_sub_u32 v46, 255, v44
    v_lshlrev_b32 v46, 4, v46
    v_add_u32 v46, s45, v46
    v_lshl_add_u32 v47, v33, 6, v32
    v_lshlrev_b32 v47, 2, v47
    v_add_u32 v47, s46, v47
    v_lshlrev_b32 v48, 2, v0
    v_add_u32 v48, s46, v48
    v_sub_u32 v49, 63, v0
    v_lshlrev_b32 v49, 4, v49
    v_add_u32 v49, s45, v49
    v_and_b32 v50, 1, v0
    v_cmp_eq_u32 vcc, 1, v50
    v_mov_b32 v51, 0x07060100
    v_mov_b32 v50, 0x03020100
    v_cndmask_b32 v50, v51, v50, vcc
    v_mov_b32 v80, 0x03020100
    v_cndmask_b32 v51, v80, v51, s[62:63]
    v_bfe_u32 v5, v32, 1, 2
    v_xor_b32 v5, v5, v33
    v_lshlrev_b32 v5, 4, v5
    v_lshl_add_u32 v5, v32, 6, v5
    s_mul_i32 s61, s3, 2048
    s_add_u32 s61, s61, 88064
    v_add_u32 v5, s61, v5
    s_barrier
    ds_read_b128 v[148:151], v34 offset:1024
    ds_read_b128 v[152:155], v34 offset:2048
    ds_read_b128 v[144:147], v34 offset:0
    s_waitcnt lgkmcnt(1)
    v_add_f32 v132, v132, v148
    v_add_f32 v133, v133, v149
    v_add_f32 v134, v134, v150
    v_add_f32 v135, v135, v151
    v_add_f32 v136, v136, v152
    v_add_f32 v137, v137, v153
    v_add_f32 v138, v138, v154
    v_add_f32 v139, v139, v155
    v_cvt_pk_bf16_f32 v55, v132, v132
    v_cvt_pk_bf16_f32 v59, v134, v134
    v_cvt_pk_bf16_f32 v62, v136, v136
    v_cvt_pk_bf16_f32 v63, v137, v137
    v_cvt_pk_bf16_f32 v64, v138, v138
    v_cvt_pk_bf16_f32 v65, v139, v139
    ds_write_b32 v45, v55
    s_mov_b64 exec, s[58:59]
    s_mov_b32 exec_hi, -1
    ds_write_b32 v45, v59 offset:64
    s_mov_b64 exec, s[56:57]
    ds_write_b32 v47, v62 offset:512
    ds_write_b32 v47, v63 offset:576
    ds_write_b32 v47, v64 offset:640
    ds_write_b32 v47, v65 offset:704
    ds_read_b32 v52, v45 offset:4
    ds_read_b32 v56, v45 offset:68
    ds_read2_b32 v[66:67], v48 offset0:128 offset1:129
    ds_read2_b32 v[74:75], v48 offset0:192 offset1:193
    s_waitcnt lgkmcnt(10)
    v_add_f32 v128, v128, v144
    v_add_f32 v129, v129, v145
    v_add_f32 v130, v130, v146
    v_add_f32 v131, v131, v147
    v_cvt_pk_bf16_f32 v42, v131, v130
    v_cvt_pk_bf16_f32 v43, v129, v128
    ds_write_b64 v40, v[42:43]
    v_cndmask_b32 v60, v133, v134, s[62:63]
    v_cndmask_b32 v61, v132, v133, s[62:63]
    v_cvt_pk_bf16_f32 v53, v60, v60
    v_cvt_pk_bf16_f32 v54, v60, v61
    v_cvt_pk_bf16_f32 v57, v135, v135
    v_cvt_pk_bf16_f32 v58, v135, v134
    s_waitcnt lgkmcnt(3)
    v_perm_b32 v52, v57, v52, v51
    ds_write_b128 v46, v[52:55]
    s_mov_b64 exec, s[58:59]
    s_mov_b32 exec_hi, -1
    v_subrev_u32 v46, 256, v46
    ds_write_b128 v46, v[56:59]
    s_mov_b64 exec, s[56:57]
    s_waitcnt lgkmcnt(3)
    v_mov_b32 v64, v67
    v_perm_b32 v65, v66, v67, v50
    v_mov_b32 v67, v66
    ds_write_b128 v49, v[64:67] offset:1024
    v_mov_b32 v72, v75
    v_perm_b32 v73, v74, v75, v50
    v_mov_b32 v75, v74
    ds_write_b128 v49, v[72:75] offset:0
    ds_read_b128 v[40:43], v8 offset:3584
    ds_read_b128 v[44:47], v8 offset:3072
    ds_read_b128 v[48:51], v8 offset:3648
    ds_read_b128 v[52:55], v8 offset:3136
    ds_read_b128 v[56:59], v8 offset:3712
    ds_read_b128 v[60:63], v8 offset:3200
    ds_read_b128 v[64:67], v8 offset:3776
    ds_read_b128 v[68:71], v8 offset:3264
    s_barrier
    ds_read_b128 v[72:75], v9 offset:0
    ds_read_b128 v[76:79], v9 offset:512
    ds_read_b128 v[80:83], v9 offset:64
    ds_read_b128 v[84:87], v9 offset:576
    s_waitcnt lgkmcnt(3)
    v_mfma_f32_16x16x32_bf16 v[24:27], v[72:75], v[40:43], 0
    ds_read_b128 v[88:91], v9 offset:128
    v_mfma_f32_16x16x32_bf16 v[28:31], v[72:75], v[44:47], 0
    ds_read_b128 v[92:95], v9 offset:640
    s_waitcnt lgkmcnt(4)
    v_mfma_f32_16x16x32_bf16 v[28:31], v[76:79], v[40:43], v[28:31]
    ds_read_b128 v[96:99], v9 offset:192
    s_waitcnt lgkmcnt(4)
    v_mfma_f32_16x16x32_bf16 v[24:27], v[80:83], v[48:51], v[24:27]
    ds_read_b128 v[100:103], v9 offset:704
    v_mfma_f32_16x16x32_bf16 v[28:31], v[80:83], v[52:55], v[28:31]
    ds_read_b128 v[104:107], v9 offset:256
    s_waitcnt lgkmcnt(5)
    v_mfma_f32_16x16x32_bf16 v[28:31], v[84:87], v[48:51], v[28:31]
    ds_read_b128 v[108:111], v8 offset:3840
    s_waitcnt lgkmcnt(5)
    v_mfma_f32_16x16x32_bf16 v[24:27], v[88:91], v[56:59], v[24:27]
    ds_read_b128 v[112:115], v8 offset:3328
    v_mfma_f32_16x16x32_bf16 v[28:31], v[88:91], v[60:63], v[28:31]
    ds_read_b128 v[116:119], v9 offset:768
    s_waitcnt lgkmcnt(6)
    v_mfma_f32_16x16x32_bf16 v[28:31], v[92:95], v[56:59], v[28:31]
    ds_read_b128 v[120:123], v9 offset:320
    s_waitcnt lgkmcnt(6)
    v_mfma_f32_16x16x32_bf16 v[24:27], v[96:99], v[64:67], v[24:27]
    ds_read_b128 v[124:127], v8 offset:3904
    v_mfma_f32_16x16x32_bf16 v[28:31], v[96:99], v[68:71], v[28:31]
    ds_read_b128 v[128:131], v8 offset:3392
    s_waitcnt lgkmcnt(7)
    v_mfma_f32_16x16x32_bf16 v[28:31], v[100:103], v[64:67], v[28:31]
    ds_read_b128 v[132:135], v9 offset:832
    s_waitcnt lgkmcnt(7)
    s_waitcnt lgkmcnt(6)
    v_mfma_f32_16x16x32_bf16 v[24:27], v[104:107], v[108:111], v[24:27]
    ds_read_b128 v[136:139], v9 offset:384
    s_waitcnt lgkmcnt(6)
    v_mfma_f32_16x16x32_bf16 v[28:31], v[104:107], v[112:115], v[28:31]
    ds_read_b128 v[140:143], v8 offset:3968
    s_waitcnt lgkmcnt(6)
    v_mfma_f32_16x16x32_bf16 v[28:31], v[116:119], v[108:111], v[28:31]
    ds_read_b128 v[144:147], v8 offset:3456
    s_waitcnt lgkmcnt(6)
    s_waitcnt lgkmcnt(5)
    v_mfma_f32_16x16x32_bf16 v[24:27], v[120:123], v[124:127], v[24:27]
    ds_read_b128 v[148:151], v9 offset:896
    s_waitcnt lgkmcnt(5)
    v_mfma_f32_16x16x32_bf16 v[28:31], v[120:123], v[128:131], v[28:31]
    ds_read_b128 v[152:155], v9 offset:448
    s_waitcnt lgkmcnt(5)
    v_mfma_f32_16x16x32_bf16 v[28:31], v[132:135], v[124:127], v[28:31]
    ds_read_b128 v[156:159], v8 offset:4032
    s_waitcnt lgkmcnt(5)
    s_waitcnt lgkmcnt(4)
    v_mfma_f32_16x16x32_bf16 v[24:27], v[136:139], v[140:143], v[24:27]
    ds_read_b128 v[160:163], v8 offset:3520
    s_waitcnt lgkmcnt(4)
    v_mfma_f32_16x16x32_bf16 v[28:31], v[136:139], v[144:147], v[28:31]
    ds_read_b128 v[164:167], v9 offset:960
    s_waitcnt lgkmcnt(4)
    v_mfma_f32_16x16x32_bf16 v[28:31], v[148:151], v[140:143], v[28:31]
    ds_read_b128 v[168:171], v8 offset:2560
    s_waitcnt lgkmcnt(4)
    s_waitcnt lgkmcnt(3)
    v_mfma_f32_16x16x32_bf16 v[24:27], v[152:155], v[156:159], v[24:27]
    ds_read_b128 v[172:175], v8 offset:2048
    s_waitcnt lgkmcnt(3)
    v_mfma_f32_16x16x32_bf16 v[28:31], v[152:155], v[160:163], v[28:31]
    ds_read_b128 v[176:179], v8 offset:2624
    s_waitcnt lgkmcnt(3)
    v_mfma_f32_16x16x32_bf16 v[28:31], v[164:167], v[156:159], v[28:31]
    ds_read_b128 v[180:183], v8 offset:2112
    s_waitcnt lgkmcnt(3)
    v_mfma_f32_16x16x32_bf16 v[32:35], v[72:75], v[168:171], 0
    ds_read_b128 v[184:187], v8 offset:2688
    s_waitcnt lgkmcnt(3)
    v_mfma_f32_16x16x32_bf16 v[36:39], v[72:75], v[172:175], 0
    ds_read_b128 v[188:191], v8 offset:2176
    v_mfma_f32_16x16x32_bf16 v[32:35], v[76:79], v[44:47], v[32:35]
    ds_read_b128 v[192:195], v8 offset:2752
    ds_write_b128 v5, v[24:27] offset:0
    ds_write_b128 v5, v[28:31] offset:1024
    v_mfma_f32_16x16x32_bf16 v[36:39], v[76:79], v[168:171], v[36:39]
    ds_read_b128 v[196:199], v8 offset:2240
    s_waitcnt lgkmcnt(7)
    v_mfma_f32_16x16x32_bf16 v[32:35], v[80:83], v[176:179], v[32:35]
    ds_read_b128 v[200:203], v8 offset:2816
    s_waitcnt lgkmcnt(7)
    v_mfma_f32_16x16x32_bf16 v[36:39], v[80:83], v[180:183], v[36:39]
    ds_read_b128 v[204:207], v8 offset:2304
    v_mfma_f32_16x16x32_bf16 v[32:35], v[84:87], v[52:55], v[32:35]
    ds_read_b128 v[208:211], v8 offset:2880
    v_mfma_f32_16x16x32_bf16 v[36:39], v[84:87], v[176:179], v[36:39]
    ds_read_b128 v[212:215], v8 offset:2368
    s_waitcnt lgkmcnt(9)
    v_mfma_f32_16x16x32_bf16 v[32:35], v[88:91], v[184:187], v[32:35]
    ds_read_b128 v[216:219], v8 offset:2944
    s_waitcnt lgkmcnt(9)
    v_mfma_f32_16x16x32_bf16 v[36:39], v[88:91], v[188:191], v[36:39]
    ds_read_b128 v[220:223], v8 offset:2432
    v_mfma_f32_16x16x32_bf16 v[32:35], v[92:95], v[60:63], v[32:35]
    v_mfma_f32_16x16x32_bf16 v[36:39], v[92:95], v[184:187], v[36:39]
    s_waitcnt lgkmcnt(9)
    v_mfma_f32_16x16x32_bf16 v[32:35], v[96:99], v[192:195], v[32:35]
    ds_read_b128 v[224:227], v8 offset:3008
    s_waitcnt lgkmcnt(7)
    v_mfma_f32_16x16x32_bf16 v[36:39], v[96:99], v[196:199], v[36:39]
    ds_read_b128 v[228:231], v8 offset:2496
    v_mfma_f32_16x16x32_bf16 v[32:35], v[100:103], v[68:71], v[32:35]
    v_mfma_f32_16x16x32_bf16 v[36:39], v[100:103], v[192:195], v[36:39]
    s_waitcnt lgkmcnt(7)
    v_mfma_f32_16x16x32_bf16 v[32:35], v[104:107], v[200:203], v[32:35]
    s_waitcnt lgkmcnt(6)
    v_mfma_f32_16x16x32_bf16 v[36:39], v[104:107], v[204:207], v[36:39]
    v_mfma_f32_16x16x32_bf16 v[32:35], v[116:119], v[112:115], v[32:35]
    v_mfma_f32_16x16x32_bf16 v[36:39], v[116:119], v[200:203], v[36:39]
    s_barrier
    ds_read_b128 v[232:235], v9 offset:1024
    ds_read_b128 v[236:239], v9 offset:1536
    ds_read_b128 v[240:243], v9 offset:1088
    s_waitcnt lgkmcnt(8)
    v_mfma_f32_16x16x32_bf16 v[32:35], v[120:123], v[208:211], v[32:35]
    ds_read_b128 v[244:247], v9 offset:1600
    s_waitcnt lgkmcnt(8)
    v_mfma_f32_16x16x32_bf16 v[36:39], v[120:123], v[212:215], v[36:39]
    ds_read_b128 v[212:215], v9 offset:1152
    v_mfma_f32_16x16x32_bf16 v[32:35], v[132:135], v[128:131], v[32:35]
    v_mfma_f32_16x16x32_bf16 v[36:39], v[132:135], v[208:211], v[36:39]
    ds_read_b128 v[208:211], v9 offset:1664
    s_waitcnt lgkmcnt(9)
    v_mfma_f32_16x16x32_bf16 v[32:35], v[136:139], v[216:219], v[32:35]
    ds_read_b128 v[132:135], v9 offset:1216
    s_waitcnt lgkmcnt(9)
    v_mfma_f32_16x16x32_bf16 v[36:39], v[136:139], v[220:223], v[36:39]
    v_mfma_f32_16x16x32_bf16 v[32:35], v[148:151], v[144:147], v[32:35]
    ds_read_b128 v[220:223], v9 offset:1728
    v_mfma_f32_16x16x32_bf16 v[36:39], v[148:151], v[216:219], v[36:39]
    ds_read_b128 v[216:219], v9 offset:1280
    s_waitcnt lgkmcnt(10)
    v_mfma_f32_16x16x32_bf16 v[32:35], v[152:155], v[224:227], v[32:35]
    s_waitcnt lgkmcnt(9)
    v_mfma_f32_16x16x32_bf16 v[36:39], v[152:155], v[228:231], v[36:39]
    ds_read_b128 v[228:231], v9 offset:1792
    v_mfma_f32_16x16x32_bf16 v[32:35], v[164:167], v[160:163], v[32:35]
    ds_read_b128 v[152:155], v9 offset:1344
    v_mfma_f32_16x16x32_bf16 v[36:39], v[164:167], v[224:227], v[36:39]
    s_waitcnt lgkmcnt(10)
    v_mfma_f32_16x16x32_bf16 v[32:35], v[232:235], v[40:43], v[32:35]
    ds_read_b128 v[224:227], v9 offset:1856
    v_mfma_f32_16x16x32_bf16 v[36:39], v[232:235], v[44:47], v[36:39]
    ds_read_b128 v[164:167], v9 offset:1408
    s_waitcnt lgkmcnt(11)
    v_mfma_f32_16x16x32_bf16 v[36:39], v[236:239], v[40:43], v[36:39]
    s_waitcnt lgkmcnt(10)
    v_mfma_f32_16x16x32_bf16 v[32:35], v[240:243], v[48:51], v[32:35]
    ds_read_b128 v[40:43], v9 offset:1920
    v_mfma_f32_16x16x32_bf16 v[36:39], v[240:243], v[52:55], v[36:39]
    ds_read_b128 v[148:151], v9 offset:1472
    s_waitcnt lgkmcnt(11)
    v_mfma_f32_16x16x32_bf16 v[36:39], v[244:247], v[48:51], v[36:39]
    s_waitcnt lgkmcnt(10)
    v_mfma_f32_16x16x32_bf16 v[32:35], v[212:215], v[56:59], v[32:35]
    ds_read_b128 v[48:51], v9 offset:1984
    v_mfma_f32_16x16x32_bf16 v[36:39], v[212:215], v[60:63], v[36:39]
    ds_read_b128 v[136:139], v8 offset:1536
    s_waitcnt lgkmcnt(11)
    v_mfma_f32_16x16x32_bf16 v[36:39], v[208:211], v[56:59], v[36:39]
    ds_read_b128 v[56:59], v8 offset:1024
    s_waitcnt lgkmcnt(11)
    v_mfma_f32_16x16x32_bf16 v[32:35], v[132:135], v[64:67], v[32:35]
    v_mfma_f32_16x16x32_bf16 v[36:39], v[132:135], v[68:71], v[36:39]
    s_waitcnt lgkmcnt(10)
    v_mfma_f32_16x16x32_bf16 v[36:39], v[220:223], v[64:67], v[36:39]
    s_waitcnt lgkmcnt(9)
    v_mfma_f32_16x16x32_bf16 v[32:35], v[216:219], v[108:111], v[32:35]
    v_mfma_f32_16x16x32_bf16 v[36:39], v[216:219], v[112:115], v[36:39]
    s_waitcnt lgkmcnt(8)
    v_mfma_f32_16x16x32_bf16 v[36:39], v[228:231], v[108:111], v[36:39]
    s_waitcnt lgkmcnt(7)
    v_mfma_f32_16x16x32_bf16 v[32:35], v[152:155], v[124:127], v[32:35]
    v_mfma_f32_16x16x32_bf16 v[36:39], v[152:155], v[128:131], v[36:39]
    ds_read_b128 v[108:111], v8 offset:1600
    s_waitcnt lgkmcnt(7)
    v_mfma_f32_16x16x32_bf16 v[36:39], v[224:227], v[124:127], v[36:39]
    ds_read_b128 v[124:127], v8 offset:1088
    s_waitcnt lgkmcnt(7)
    v_mfma_f32_16x16x32_bf16 v[32:35], v[164:167], v[140:143], v[32:35]
    v_mfma_f32_16x16x32_bf16 v[36:39], v[164:167], v[144:147], v[36:39]
    s_waitcnt lgkmcnt(6)
    v_mfma_f32_16x16x32_bf16 v[36:39], v[40:43], v[140:143], v[36:39]
    s_waitcnt lgkmcnt(5)
    v_mfma_f32_16x16x32_bf16 v[32:35], v[148:151], v[156:159], v[32:35]
    v_mfma_f32_16x16x32_bf16 v[36:39], v[148:151], v[160:163], v[36:39]
    s_waitcnt lgkmcnt(4)
    v_mfma_f32_16x16x32_bf16 v[36:39], v[48:51], v[156:159], v[36:39]
    s_waitcnt lgkmcnt(3)
    v_mfma_f32_16x16x32_bf16 v[24:27], v[72:75], v[136:139], 0
    ds_read_b128 v[156:159], v8 offset:1664
    s_waitcnt lgkmcnt(3)
    v_mfma_f32_16x16x32_bf16 v[28:31], v[72:75], v[56:59], 0
    ds_read_b128 v[56:59], v8 offset:1152
    v_mfma_f32_16x16x32_bf16 v[24:27], v[76:79], v[172:175], v[24:27]
    ds_write_b128 v5, v[32:35] offset:8192
    ds_write_b128 v5, v[36:39] offset:9216
    v_mfma_f32_16x16x32_bf16 v[28:31], v[76:79], v[136:139], v[28:31]
    v_mfma_f32_16x16x32_bf16 v[24:27], v[232:235], v[168:171], v[24:27]
    v_mfma_f32_16x16x32_bf16 v[28:31], v[232:235], v[172:175], v[28:31]
    v_mfma_f32_16x16x32_bf16 v[24:27], v[236:239], v[44:47], v[24:27]
    v_mfma_f32_16x16x32_bf16 v[28:31], v[236:239], v[168:171], v[28:31]
    ds_read_b128 v[168:171], v8 offset:1728
    s_waitcnt lgkmcnt(6)
    v_mfma_f32_16x16x32_bf16 v[24:27], v[80:83], v[108:111], v[24:27]
    ds_read_b128 v[172:175], v8 offset:1216
    s_waitcnt lgkmcnt(6)
    v_mfma_f32_16x16x32_bf16 v[28:31], v[80:83], v[124:127], v[28:31]
    v_mfma_f32_16x16x32_bf16 v[24:27], v[84:87], v[180:183], v[24:27]
    v_mfma_f32_16x16x32_bf16 v[28:31], v[84:87], v[108:111], v[28:31]
    v_mfma_f32_16x16x32_bf16 v[24:27], v[240:243], v[176:179], v[24:27]
    v_mfma_f32_16x16x32_bf16 v[28:31], v[240:243], v[180:183], v[28:31]
    v_mfma_f32_16x16x32_bf16 v[24:27], v[244:247], v[52:55], v[24:27]
    v_mfma_f32_16x16x32_bf16 v[28:31], v[244:247], v[176:179], v[28:31]
    ds_read_b128 v[176:179], v8 offset:1792
    s_waitcnt lgkmcnt(6)
    v_mfma_f32_16x16x32_bf16 v[24:27], v[88:91], v[156:159], v[24:27]
    ds_read_b128 v[180:183], v8 offset:1280
    s_waitcnt lgkmcnt(6)
    v_mfma_f32_16x16x32_bf16 v[28:31], v[88:91], v[56:59], v[28:31]
    v_mfma_f32_16x16x32_bf16 v[24:27], v[92:95], v[188:191], v[24:27]
    v_mfma_f32_16x16x32_bf16 v[28:31], v[92:95], v[156:159], v[28:31]
    v_mfma_f32_16x16x32_bf16 v[24:27], v[212:215], v[184:187], v[24:27]
    v_mfma_f32_16x16x32_bf16 v[28:31], v[212:215], v[188:191], v[28:31]
    v_mfma_f32_16x16x32_bf16 v[24:27], v[208:211], v[60:63], v[24:27]
    v_mfma_f32_16x16x32_bf16 v[28:31], v[208:211], v[184:187], v[28:31]
    ds_read_b128 v[184:187], v8 offset:1856
    s_waitcnt lgkmcnt(4)
    v_mfma_f32_16x16x32_bf16 v[24:27], v[96:99], v[168:171], v[24:27]
    ds_read_b128 v[188:191], v8 offset:1344
    s_waitcnt lgkmcnt(4)
    v_mfma_f32_16x16x32_bf16 v[28:31], v[96:99], v[172:175], v[28:31]
    ds_read_b128 v[172:175], v9 offset:832
    v_mfma_f32_16x16x32_bf16 v[24:27], v[100:103], v[196:199], v[24:27]
    ds_read_b128 v[96:99], v8 offset:2368
    v_mfma_f32_16x16x32_bf16 v[28:31], v[100:103], v[168:171], v[28:31]
    ds_read_b128 v[168:171], v8 offset:2880
    v_mfma_f32_16x16x32_bf16 v[24:27], v[132:135], v[192:195], v[24:27]
    v_mfma_f32_16x16x32_bf16 v[28:31], v[132:135], v[196:199], v[28:31]
    v_mfma_f32_16x16x32_bf16 v[24:27], v[220:223], v[68:71], v[24:27]
    v_mfma_f32_16x16x32_bf16 v[28:31], v[220:223], v[192:195], v[28:31]
    ds_read_b128 v[192:195], v9 offset:384
    s_waitcnt lgkmcnt(7)
    v_mfma_f32_16x16x32_bf16 v[24:27], v[104:107], v[176:179], v[24:27]
    ds_read_b128 v[196:199], v8 offset:1920
    s_waitcnt lgkmcnt(7)
    v_mfma_f32_16x16x32_bf16 v[28:31], v[104:107], v[180:183], v[28:31]
    ds_read_b128 v[180:183], v8 offset:1408
    v_mfma_f32_16x16x32_bf16 v[24:27], v[116:119], v[204:207], v[24:27]
    ds_read_b128 v[104:107], v9 offset:896
    v_mfma_f32_16x16x32_bf16 v[28:31], v[116:119], v[176:179], v[28:31]
    ds_read_b128 v[176:179], v8 offset:2432
    v_mfma_f32_16x16x32_bf16 v[24:27], v[216:219], v[200:203], v[24:27]
    ds_read_b128 v[116:119], v8 offset:2944
    v_mfma_f32_16x16x32_bf16 v[28:31], v[216:219], v[204:207], v[28:31]
    v_mfma_f32_16x16x32_bf16 v[24:27], v[228:231], v[112:115], v[24:27]
    v_mfma_f32_16x16x32_bf16 v[28:31], v[228:231], v[200:203], v[28:31]
    s_waitcnt lgkmcnt(10)
    v_mfma_f32_16x16x32_bf16 v[24:27], v[120:123], v[184:187], v[24:27]
    ds_read_b128 v[200:203], v9 offset:448
    s_waitcnt lgkmcnt(10)
    v_mfma_f32_16x16x32_bf16 v[28:31], v[120:123], v[188:191], v[28:31]
    ds_read_b128 v[188:191], v8 offset:1984
    s_waitcnt lgkmcnt(10)
    s_waitcnt lgkmcnt(9)
    v_mfma_f32_16x16x32_bf16 v[24:27], v[172:175], v[96:99], v[24:27]
    ds_read_b128 v[120:123], v8 offset:1472
    v_mfma_f32_16x16x32_bf16 v[28:31], v[172:175], v[184:187], v[28:31]
    ds_read_b128 v[184:187], v9 offset:960
    s_waitcnt lgkmcnt(10)
    v_mfma_f32_16x16x32_bf16 v[24:27], v[152:155], v[168:171], v[24:27]
    ds_read_b128 v[172:175], v8 offset:2496
    v_mfma_f32_16x16x32_bf16 v[28:31], v[152:155], v[96:99], v[28:31]
    ds_read_b128 v[96:99], v8 offset:3008
    v_mfma_f32_16x16x32_bf16 v[24:27], v[224:227], v[128:131], v[24:27]
    v_mfma_f32_16x16x32_bf16 v[28:31], v[224:227], v[168:171], v[28:31]
    s_waitcnt lgkmcnt(11)
    s_waitcnt lgkmcnt(10)
    v_mfma_f32_16x16x32_bf16 v[24:27], v[192:195], v[196:199], v[24:27]
    s_waitcnt lgkmcnt(9)
    v_mfma_f32_16x16x32_bf16 v[28:31], v[192:195], v[180:183], v[28:31]
    s_waitcnt lgkmcnt(8)
    s_waitcnt lgkmcnt(7)
    v_mfma_f32_16x16x32_bf16 v[24:27], v[104:107], v[176:179], v[24:27]
    v_mfma_f32_16x16x32_bf16 v[28:31], v[104:107], v[196:199], v[28:31]
    s_barrier
    ds_read_b128 v[196:199], v9 offset:2048
    ds_read_b128 v[180:183], v8 offset:3584
    ds_read_b128 v[104:107], v9 offset:2560
    ds_read_b128 v[192:195], v9 offset:2112
    ds_read_b128 v[168:171], v8 offset:3648
    s_waitcnt lgkmcnt(11)
    v_mfma_f32_16x16x32_bf16 v[24:27], v[164:167], v[116:119], v[24:27]
    ds_read_b128 v[224:227], v9 offset:2624
    v_mfma_f32_16x16x32_bf16 v[28:31], v[164:167], v[176:179], v[28:31]
    v_mfma_f32_16x16x32_bf16 v[24:27], v[40:43], v[144:147], v[24:27]
    v_mfma_f32_16x16x32_bf16 v[28:31], v[40:43], v[116:119], v[28:31]
    s_waitcnt lgkmcnt(11)
    s_waitcnt lgkmcnt(10)
    v_mfma_f32_16x16x32_bf16 v[24:27], v[200:203], v[188:191], v[24:27]
    ds_read_b128 v[116:119], v9 offset:2176
    s_waitcnt lgkmcnt(10)
    v_mfma_f32_16x16x32_bf16 v[28:31], v[200:203], v[120:123], v[28:31]
    ds_read_b128 v[120:123], v8 offset:3712
    s_waitcnt lgkmcnt(10)
    s_waitcnt lgkmcnt(9)
    v_mfma_f32_16x16x32_bf16 v[24:27], v[184:187], v[172:175], v[24:27]
    ds_read_b128 v[200:203], v9 offset:2688
    v_mfma_f32_16x16x32_bf16 v[28:31], v[184:187], v[188:191], v[28:31]
    ds_read_b128 v[188:191], v9 offset:2240
    s_waitcnt lgkmcnt(10)
    v_mfma_f32_16x16x32_bf16 v[24:27], v[148:151], v[96:99], v[24:27]
    ds_read_b128 v[184:187], v9 offset:2752
    v_mfma_f32_16x16x32_bf16 v[28:31], v[148:151], v[172:175], v[28:31]
    ds_read_b128 v[172:175], v9 offset:2304
    v_mfma_f32_16x16x32_bf16 v[24:27], v[48:51], v[160:163], v[24:27]
    v_mfma_f32_16x16x32_bf16 v[28:31], v[48:51], v[96:99], v[28:31]
    s_waitcnt lgkmcnt(11)
    s_waitcnt lgkmcnt(10)
    v_mfma_f32_16x16x32_bf16 v[24:27], v[196:199], v[180:183], v[24:27]
    ds_read_b128 v[96:99], v8 offset:3840
    v_mfma_f32_16x16x32_bf16 v[28:31], v[196:199], v[44:47], v[28:31]
    ds_read_b128 v[48:51], v9 offset:2816
    s_waitcnt lgkmcnt(11)
    v_mfma_f32_16x16x32_bf16 v[28:31], v[104:107], v[180:183], v[28:31]
    ds_read_b128 v[180:183], v9 offset:2368
    s_waitcnt lgkmcnt(11)
    s_waitcnt lgkmcnt(10)
    v_mfma_f32_16x16x32_bf16 v[24:27], v[192:195], v[168:171], v[24:27]
    ds_read_b128 v[148:151], v8 offset:3904
    v_mfma_f32_16x16x32_bf16 v[28:31], v[192:195], v[52:55], v[28:31]
    ds_read_b128 v[40:43], v9 offset:2880
    s_waitcnt lgkmcnt(11)
    v_mfma_f32_16x16x32_bf16 v[28:31], v[224:227], v[168:171], v[28:31]
    ds_read_b128 v[168:171], v9 offset:2432
    s_waitcnt lgkmcnt(11)
    s_waitcnt lgkmcnt(10)
    v_mfma_f32_16x16x32_bf16 v[24:27], v[116:119], v[120:123], v[24:27]
    ds_read_b128 v[176:179], v9 offset:2944
    v_mfma_f32_16x16x32_bf16 v[28:31], v[116:119], v[60:63], v[28:31]
    ds_read_b128 v[164:167], v9 offset:2496
    s_waitcnt lgkmcnt(11)
    v_mfma_f32_16x16x32_bf16 v[28:31], v[200:203], v[120:123], v[28:31]
    ds_read_b128 v[120:123], v8 offset:4032
    s_waitcnt lgkmcnt(11)
    v_mfma_f32_16x16x32_bf16 v[24:27], v[188:191], v[64:67], v[24:27]
    ds_read_b128 v[152:155], v9 offset:3008
    v_mfma_f32_16x16x32_bf16 v[28:31], v[188:191], v[68:71], v[28:31]
    s_waitcnt lgkmcnt(11)
    v_mfma_f32_16x16x32_bf16 v[28:31], v[184:187], v[64:67], v[28:31]
    ds_read_b128 v[64:67], v8 offset:512
    s_waitcnt lgkmcnt(11)
    s_waitcnt lgkmcnt(10)
    v_mfma_f32_16x16x32_bf16 v[24:27], v[172:175], v[96:99], v[24:27]
    ds_read_b128 v[204:207], v8 offset:0
    v_mfma_f32_16x16x32_bf16 v[28:31], v[172:175], v[112:115], v[28:31]
    ds_read_b128 v[112:115], v8 offset:1024
    s_waitcnt lgkmcnt(11)
    v_mfma_f32_16x16x32_bf16 v[28:31], v[48:51], v[96:99], v[28:31]
    ds_read_b128 v[96:99], v8 offset:2048
    s_waitcnt lgkmcnt(11)
    s_waitcnt lgkmcnt(10)
    v_mfma_f32_16x16x32_bf16 v[24:27], v[180:183], v[148:151], v[24:27]
    v_mfma_f32_16x16x32_bf16 v[28:31], v[180:183], v[128:131], v[28:31]
    ds_read_b128 v[128:131], v8 offset:2560
    s_waitcnt lgkmcnt(10)
    v_mfma_f32_16x16x32_bf16 v[28:31], v[40:43], v[148:151], v[28:31]
    s_waitcnt lgkmcnt(9)
    v_mfma_f32_16x16x32_bf16 v[24:27], v[168:171], v[140:143], v[24:27]
    v_mfma_f32_16x16x32_bf16 v[28:31], v[168:171], v[144:147], v[28:31]
    s_waitcnt lgkmcnt(8)
    v_mfma_f32_16x16x32_bf16 v[28:31], v[176:179], v[140:143], v[28:31]
    s_waitcnt lgkmcnt(7)
    s_waitcnt lgkmcnt(6)
    v_mfma_f32_16x16x32_bf16 v[24:27], v[164:167], v[120:123], v[24:27]
    ds_read_b128 v[140:143], v8 offset:576
    v_mfma_f32_16x16x32_bf16 v[28:31], v[164:167], v[160:163], v[28:31]
    ds_read_b128 v[148:151], v8 offset:64
    s_waitcnt lgkmcnt(7)
    v_mfma_f32_16x16x32_bf16 v[28:31], v[152:155], v[120:123], v[28:31]
    s_waitcnt lgkmcnt(6)
    v_mfma_f32_16x16x32_bf16 v[32:35], v[72:75], v[64:67], 0
    s_waitcnt lgkmcnt(5)
    v_mfma_f32_16x16x32_bf16 v[36:39], v[72:75], v[204:207], 0
    s_waitcnt lgkmcnt(4)
    v_mfma_f32_16x16x32_bf16 v[32:35], v[76:79], v[112:115], v[32:35]
    ds_write_b128 v5, v[24:27] offset:16384
    s_nop 0
    ds_write_b128 v5, v[28:31] offset:17408
    v_mfma_f32_16x16x32_bf16 v[36:39], v[76:79], v[64:67], v[36:39]
    ds_read_b128 v[72:75], v8 offset:2112
    v_mfma_f32_16x16x32_bf16 v[32:35], v[232:235], v[136:139], v[32:35]
    ds_read_b128 v[204:207], v8 offset:2624
    v_mfma_f32_16x16x32_bf16 v[36:39], v[232:235], v[112:115], v[36:39]
    s_waitcnt lgkmcnt(7)
    v_mfma_f32_16x16x32_bf16 v[32:35], v[236:239], v[96:99], v[32:35]
    v_mfma_f32_16x16x32_bf16 v[36:39], v[236:239], v[136:139], v[36:39]
    s_waitcnt lgkmcnt(6)
    v_mfma_f32_16x16x32_bf16 v[32:35], v[196:199], v[128:131], v[32:35]
    ds_read_b128 v[76:79], v8 offset:640
    v_mfma_f32_16x16x32_bf16 v[36:39], v[196:199], v[96:99], v[36:39]
    ds_read_b128 v[64:67], v8 offset:128
    s_waitcnt lgkmcnt(4)
    s_barrier
    v_mfma_f32_16x16x32_bf16 v[32:35], v[104:107], v[44:47], v[32:35]
    v_mfma_f32_16x16x32_bf16 v[36:39], v[104:107], v[128:131], v[36:39]
    v_mfma_f32_16x16x32_bf16 v[32:35], v[80:83], v[140:143], v[32:35]
    v_mfma_f32_16x16x32_bf16 v[36:39], v[80:83], v[148:151], v[36:39]
    ds_read_b128 v[232:235], v8 offset:2176
    v_mfma_f32_16x16x32_bf16 v[32:35], v[84:87], v[124:127], v[32:35]
    v_mfma_f32_16x16x32_bf16 v[36:39], v[84:87], v[140:143], v[36:39]
    ds_read_b128 v[112:115], v8 offset:2688
    v_mfma_f32_16x16x32_bf16 v[32:35], v[240:243], v[108:111], v[32:35]
    v_mfma_f32_16x16x32_bf16 v[36:39], v[240:243], v[124:127], v[36:39]
    s_waitcnt lgkmcnt(5)
    v_mfma_f32_16x16x32_bf16 v[32:35], v[244:247], v[72:75], v[32:35]
    v_mfma_f32_16x16x32_bf16 v[36:39], v[244:247], v[108:111], v[36:39]
    ds_read_b128 v[236:239], v9 offset:192
    s_waitcnt lgkmcnt(5)
    v_mfma_f32_16x16x32_bf16 v[32:35], v[192:195], v[204:207], v[32:35]
    ds_read_b128 v[136:139], v8 offset:704
    v_mfma_f32_16x16x32_bf16 v[36:39], v[192:195], v[72:75], v[36:39]
    ds_read_b128 v[196:199], v8 offset:192
    v_mfma_f32_16x16x32_bf16 v[32:35], v[224:227], v[52:55], v[32:35]
    ds_read_b128 v[96:99], v8 offset:1216
    v_mfma_f32_16x16x32_bf16 v[36:39], v[224:227], v[204:207], v[36:39]
    ds_read_b128 v[104:107], v8 offset:1728
    s_waitcnt lgkmcnt(8)
    v_mfma_f32_16x16x32_bf16 v[32:35], v[88:91], v[76:79], v[32:35]
    s_waitcnt lgkmcnt(7)
    v_mfma_f32_16x16x32_bf16 v[36:39], v[88:91], v[64:67], v[36:39]
    ds_read_b128 v[128:131], v8 offset:2240
    v_mfma_f32_16x16x32_bf16 v[32:35], v[92:95], v[56:59], v[32:35]
    v_mfma_f32_16x16x32_bf16 v[36:39], v[92:95], v[76:79], v[36:39]
    ds_read_b128 v[80:83], v8 offset:2752
    v_mfma_f32_16x16x32_bf16 v[32:35], v[212:215], v[156:159], v[32:35]
    v_mfma_f32_16x16x32_bf16 v[36:39], v[212:215], v[56:59], v[36:39]
    s_waitcnt lgkmcnt(8)
    v_mfma_f32_16x16x32_bf16 v[32:35], v[208:211], v[232:235], v[32:35]
    v_mfma_f32_16x16x32_bf16 v[36:39], v[208:211], v[156:159], v[36:39]
    ds_read_b128 v[148:151], v9 offset:256
    s_waitcnt lgkmcnt(8)
    v_mfma_f32_16x16x32_bf16 v[32:35], v[116:119], v[112:115], v[32:35]
    ds_read_b128 v[84:87], v8 offset:768
    v_mfma_f32_16x16x32_bf16 v[36:39], v[116:119], v[232:235], v[36:39]
    ds_read_b128 v[140:143], v8 offset:256
    v_mfma_f32_16x16x32_bf16 v[32:35], v[200:203], v[60:63], v[32:35]
    ds_read_b128 v[240:243], v9 offset:768
    v_mfma_f32_16x16x32_bf16 v[36:39], v[200:203], v[112:115], v[36:39]
    ds_read_b128 v[124:127], v8 offset:1280
    s_waitcnt lgkmcnt(11)
    s_waitcnt lgkmcnt(10)
    v_mfma_f32_16x16x32_bf16 v[32:35], v[236:239], v[136:139], v[32:35]
    ds_read_b128 v[244:247], v8 offset:1792
    s_waitcnt lgkmcnt(10)
    v_mfma_f32_16x16x32_bf16 v[36:39], v[236:239], v[196:199], v[36:39]
    ds_read_b128 v[108:111], v8 offset:2304
    s_waitcnt lgkmcnt(10)
    v_mfma_f32_16x16x32_bf16 v[32:35], v[100:103], v[96:99], v[32:35]
    v_mfma_f32_16x16x32_bf16 v[36:39], v[100:103], v[136:139], v[36:39]
    ds_read_b128 v[192:195], v8 offset:2816
    s_waitcnt lgkmcnt(10)
    v_mfma_f32_16x16x32_bf16 v[32:35], v[132:135], v[104:107], v[32:35]
    v_mfma_f32_16x16x32_bf16 v[36:39], v[132:135], v[96:99], v[36:39]
    ds_read_b128 v[72:75], v8 offset:3328
    s_waitcnt lgkmcnt(10)
    v_mfma_f32_16x16x32_bf16 v[32:35], v[220:223], v[128:131], v[32:35]
    v_mfma_f32_16x16x32_bf16 v[36:39], v[220:223], v[104:107], v[36:39]
    ds_read_b128 v[224:227], v9 offset:320
    s_waitcnt lgkmcnt(10)
    v_mfma_f32_16x16x32_bf16 v[32:35], v[188:191], v[80:83], v[32:35]
    ds_read_b128 v[204:207], v8 offset:832
    v_mfma_f32_16x16x32_bf16 v[36:39], v[188:191], v[128:131], v[36:39]
    ds_read_b128 v[88:91], v8 offset:320
    v_mfma_f32_16x16x32_bf16 v[32:35], v[184:187], v[68:71], v[32:35]
    v_mfma_f32_16x16x32_bf16 v[36:39], v[184:187], v[80:83], v[36:39]
    s_waitcnt lgkmcnt(11)
    s_waitcnt lgkmcnt(10)
    v_mfma_f32_16x16x32_bf16 v[32:35], v[148:151], v[84:87], v[32:35]
    ds_read_b128 v[64:67], v9 offset:832
    s_waitcnt lgkmcnt(10)
    v_mfma_f32_16x16x32_bf16 v[36:39], v[148:151], v[140:143], v[36:39]
    ds_read_b128 v[92:95], v8 offset:1344
    s_waitcnt lgkmcnt(10)
    s_waitcnt lgkmcnt(9)
    v_mfma_f32_16x16x32_bf16 v[32:35], v[240:243], v[124:127], v[32:35]
    ds_read_b128 v[76:79], v9 offset:1344
    v_mfma_f32_16x16x32_bf16 v[36:39], v[240:243], v[84:87], v[36:39]
    ds_read_b128 v[212:215], v8 offset:1856
    s_waitcnt lgkmcnt(10)
    v_mfma_f32_16x16x32_bf16 v[32:35], v[216:219], v[244:247], v[32:35]
    ds_read_b128 v[56:59], v9 offset:1856
    v_mfma_f32_16x16x32_bf16 v[36:39], v[216:219], v[124:127], v[36:39]
    ds_read_b128 v[208:211], v8 offset:2368
    s_waitcnt lgkmcnt(11)
    v_mfma_f32_16x16x32_bf16 v[32:35], v[228:231], v[108:111], v[32:35]
    ds_read_b128 v[156:159], v8 offset:2880
    v_mfma_f32_16x16x32_bf16 v[36:39], v[228:231], v[244:247], v[36:39]
    s_waitcnt lgkmcnt(11)
    v_mfma_f32_16x16x32_bf16 v[32:35], v[172:175], v[192:195], v[32:35]
    ds_read_b128 v[116:119], v8 offset:3392
    v_mfma_f32_16x16x32_bf16 v[36:39], v[172:175], v[108:111], v[36:39]
    s_waitcnt lgkmcnt(11)
    v_mfma_f32_16x16x32_bf16 v[32:35], v[48:51], v[72:75], v[32:35]
    ds_read_b128 v[232:235], v9 offset:384
    v_mfma_f32_16x16x32_bf16 v[36:39], v[48:51], v[192:195], v[36:39]
    s_waitcnt lgkmcnt(11)
    s_waitcnt lgkmcnt(10)
    v_mfma_f32_16x16x32_bf16 v[32:35], v[224:227], v[204:207], v[32:35]
    ds_read_b128 v[200:203], v8 offset:896
    s_waitcnt lgkmcnt(10)
    v_mfma_f32_16x16x32_bf16 v[36:39], v[224:227], v[88:91], v[36:39]
    ds_read_b128 v[112:115], v8 offset:384
    s_waitcnt lgkmcnt(10)
    s_waitcnt lgkmcnt(9)
    v_mfma_f32_16x16x32_bf16 v[32:35], v[64:67], v[92:95], v[32:35]
    ds_read_b128 v[236:239], v9 offset:896
    v_mfma_f32_16x16x32_bf16 v[36:39], v[64:67], v[204:207], v[36:39]
    ds_read_b128 v[196:199], v8 offset:1408
    s_waitcnt lgkmcnt(10)
    s_waitcnt lgkmcnt(9)
    v_mfma_f32_16x16x32_bf16 v[32:35], v[76:79], v[212:215], v[32:35]
    ds_read_b128 v[100:103], v9 offset:1408
    v_mfma_f32_16x16x32_bf16 v[36:39], v[76:79], v[92:95], v[36:39]
    ds_read_b128 v[136:139], v8 offset:1920
    s_waitcnt lgkmcnt(10)
    s_waitcnt lgkmcnt(9)
    v_mfma_f32_16x16x32_bf16 v[32:35], v[56:59], v[208:211], v[32:35]
    ds_read_b128 v[132:135], v9 offset:1920
    v_mfma_f32_16x16x32_bf16 v[36:39], v[56:59], v[212:215], v[36:39]
    ds_read_b128 v[96:99], v8 offset:2432
    s_waitcnt lgkmcnt(10)
    v_mfma_f32_16x16x32_bf16 v[32:35], v[180:183], v[156:159], v[32:35]
    ds_read_b128 v[220:223], v8 offset:2944
    v_mfma_f32_16x16x32_bf16 v[36:39], v[180:183], v[208:211], v[36:39]
    ds_read_b128 v[104:107], v9 offset:448
    s_waitcnt lgkmcnt(11)
    v_mfma_f32_16x16x32_bf16 v[32:35], v[40:43], v[116:119], v[32:35]
    ds_read_b128 v[188:191], v8 offset:960
    v_mfma_f32_16x16x32_bf16 v[36:39], v[40:43], v[156:159], v[36:39]
    s_waitcnt lgkmcnt(11)
    s_waitcnt lgkmcnt(10)
    v_mfma_f32_16x16x32_bf16 v[32:35], v[232:235], v[200:203], v[32:35]
    ds_read_b128 v[128:131], v8 offset:448
    s_waitcnt lgkmcnt(10)
    v_mfma_f32_16x16x32_bf16 v[36:39], v[232:235], v[112:115], v[36:39]
    ds_read_b128 v[184:187], v9 offset:960
    s_waitcnt lgkmcnt(10)
    s_waitcnt lgkmcnt(9)
    v_mfma_f32_16x16x32_bf16 v[32:35], v[236:239], v[196:199], v[32:35]
    ds_read_b128 v[80:83], v8 offset:1472
    v_mfma_f32_16x16x32_bf16 v[36:39], v[236:239], v[200:203], v[36:39]
    ds_read_b128 v[148:151], v9 offset:1472
    s_waitcnt lgkmcnt(10)
    s_waitcnt lgkmcnt(9)
    v_mfma_f32_16x16x32_bf16 v[32:35], v[100:103], v[136:139], v[32:35]
    ds_read_b128 v[140:143], v8 offset:1984
    v_mfma_f32_16x16x32_bf16 v[36:39], v[100:103], v[196:199], v[36:39]
    ds_read_b128 v[240:243], v9 offset:1984
    s_waitcnt lgkmcnt(10)
    s_waitcnt lgkmcnt(9)
    v_mfma_f32_16x16x32_bf16 v[32:35], v[132:135], v[96:99], v[32:35]
    ds_read_b128 v[84:87], v8 offset:2496
    v_mfma_f32_16x16x32_bf16 v[36:39], v[132:135], v[136:139], v[36:39]
    ds_read_b128 v[216:219], v8 offset:3008
    s_waitcnt lgkmcnt(10)
    v_mfma_f32_16x16x32_bf16 v[32:35], v[168:171], v[220:223], v[32:35]
    v_mfma_f32_16x16x32_bf16 v[36:39], v[168:171], v[96:99], v[36:39]
    v_mfma_f32_16x16x32_bf16 v[32:35], v[176:179], v[144:147], v[32:35]
    v_mfma_f32_16x16x32_bf16 v[36:39], v[176:179], v[220:223], v[36:39]
    s_barrier
    ds_read_b128 v[124:127], v9 offset:3072
    ds_read_b128 v[228:231], v8 offset:3584
    s_waitcnt lgkmcnt(11)
    s_waitcnt lgkmcnt(10)
    v_mfma_f32_16x16x32_bf16 v[32:35], v[104:107], v[188:191], v[32:35]
    ds_read_b128 v[244:247], v9 offset:3584
    s_waitcnt lgkmcnt(10)
    v_mfma_f32_16x16x32_bf16 v[36:39], v[104:107], v[128:131], v[36:39]
    ds_read_b128 v[172:175], v9 offset:3136
    s_waitcnt lgkmcnt(10)
    s_waitcnt lgkmcnt(9)
    v_mfma_f32_16x16x32_bf16 v[32:35], v[184:187], v[80:83], v[32:35]
    ds_read_b128 v[108:111], v8 offset:3648
    v_mfma_f32_16x16x32_bf16 v[36:39], v[184:187], v[188:191], v[36:39]
    ds_read_b128 v[48:51], v9 offset:3648
    s_waitcnt lgkmcnt(10)
    s_waitcnt lgkmcnt(9)
    v_mfma_f32_16x16x32_bf16 v[32:35], v[148:151], v[140:143], v[32:35]
    ds_read_b128 v[192:195], v9 offset:3200
    v_mfma_f32_16x16x32_bf16 v[36:39], v[148:151], v[80:83], v[36:39]
    ds_read_b128 v[224:227], v8 offset:3712
    s_waitcnt lgkmcnt(10)
    s_waitcnt lgkmcnt(9)
    v_mfma_f32_16x16x32_bf16 v[32:35], v[240:243], v[84:87], v[32:35]
    ds_read_b128 v[88:91], v9 offset:3712
    v_mfma_f32_16x16x32_bf16 v[36:39], v[240:243], v[140:143], v[36:39]
    ds_read_b128 v[64:67], v9 offset:3264
    s_waitcnt lgkmcnt(10)
    v_mfma_f32_16x16x32_bf16 v[32:35], v[164:167], v[216:219], v[32:35]
    ds_read_b128 v[204:207], v8 offset:3776
    v_mfma_f32_16x16x32_bf16 v[36:39], v[164:167], v[84:87], v[36:39]
    ds_read_b128 v[76:79], v9 offset:3776
    v_mfma_f32_16x16x32_bf16 v[32:35], v[152:155], v[160:163], v[32:35]
    v_mfma_f32_16x16x32_bf16 v[36:39], v[152:155], v[216:219], v[36:39]
    s_waitcnt lgkmcnt(11)
    s_waitcnt lgkmcnt(10)
    v_mfma_f32_16x16x32_bf16 v[32:35], v[124:127], v[228:231], v[32:35]
    ds_read_b128 v[92:95], v9 offset:3328
    v_mfma_f32_16x16x32_bf16 v[36:39], v[124:127], v[44:47], v[36:39]
    ds_read_b128 v[56:59], v8 offset:3840
    s_waitcnt lgkmcnt(11)
    v_mfma_f32_16x16x32_bf16 v[36:39], v[244:247], v[228:231], v[36:39]
    ds_read_b128 v[212:215], v9 offset:3840
    s_waitcnt lgkmcnt(11)
    s_waitcnt lgkmcnt(10)
    v_mfma_f32_16x16x32_bf16 v[32:35], v[172:175], v[108:111], v[32:35]
    ds_read_b128 v[180:183], v9 offset:3392
    v_mfma_f32_16x16x32_bf16 v[36:39], v[172:175], v[52:55], v[36:39]
    ds_read_b128 v[208:211], v8 offset:3904
    s_waitcnt lgkmcnt(11)
    v_mfma_f32_16x16x32_bf16 v[36:39], v[48:51], v[108:111], v[36:39]
    ds_read_b128 v[40:43], v9 offset:3904
    s_waitcnt lgkmcnt(11)
    s_waitcnt lgkmcnt(10)
    v_mfma_f32_16x16x32_bf16 v[32:35], v[192:195], v[224:227], v[32:35]
    ds_read_b128 v[156:159], v9 offset:3456
    v_mfma_f32_16x16x32_bf16 v[36:39], v[192:195], v[60:63], v[36:39]
    ds_read_b128 v[232:235], v8 offset:3968
    s_waitcnt lgkmcnt(11)
    v_mfma_f32_16x16x32_bf16 v[36:39], v[88:91], v[224:227], v[36:39]
    ds_read_b128 v[112:115], v9 offset:3968
    s_waitcnt lgkmcnt(11)
    s_waitcnt lgkmcnt(10)
    v_mfma_f32_16x16x32_bf16 v[32:35], v[64:67], v[204:207], v[32:35]
    ds_read_b128 v[236:239], v9 offset:3520
    v_mfma_f32_16x16x32_bf16 v[36:39], v[64:67], v[68:71], v[36:39]
    ds_read_b128 v[200:203], v9 offset:4032
    s_waitcnt lgkmcnt(11)
    v_mfma_f32_16x16x32_bf16 v[36:39], v[76:79], v[204:207], v[36:39]
    s_waitcnt lgkmcnt(10)
    s_waitcnt lgkmcnt(9)
    v_mfma_f32_16x16x32_bf16 v[32:35], v[92:95], v[56:59], v[32:35]
    v_mfma_f32_16x16x32_bf16 v[36:39], v[92:95], v[72:75], v[36:39]
    s_waitcnt lgkmcnt(8)
    v_mfma_f32_16x16x32_bf16 v[36:39], v[212:215], v[56:59], v[36:39]
    s_waitcnt lgkmcnt(7)
    s_waitcnt lgkmcnt(6)
    v_mfma_f32_16x16x32_bf16 v[32:35], v[180:183], v[208:211], v[32:35]
    v_mfma_f32_16x16x32_bf16 v[36:39], v[180:183], v[116:119], v[36:39]
    s_waitcnt lgkmcnt(5)
    v_mfma_f32_16x16x32_bf16 v[36:39], v[40:43], v[208:211], v[36:39]
    s_waitcnt lgkmcnt(4)
    s_waitcnt lgkmcnt(3)
    v_mfma_f32_16x16x32_bf16 v[32:35], v[156:159], v[232:235], v[32:35]
    v_mfma_f32_16x16x32_bf16 v[36:39], v[156:159], v[144:147], v[36:39]
    s_waitcnt lgkmcnt(2)
    v_mfma_f32_16x16x32_bf16 v[36:39], v[112:115], v[232:235], v[36:39]
    s_waitcnt lgkmcnt(1)
    v_mfma_f32_16x16x32_bf16 v[32:35], v[236:239], v[120:123], v[32:35]
    v_mfma_f32_16x16x32_bf16 v[36:39], v[236:239], v[160:163], v[36:39]
    s_waitcnt lgkmcnt(0)
    v_mfma_f32_16x16x32_bf16 v[36:39], v[200:203], v[120:123], v[36:39]
    s_nop 4
    ds_write_b128 v5, v[32:35] offset:24576
    s_nop 1
    ds_write_b128 v5, v[36:39] offset:25600
    s_waitcnt lgkmcnt(0)
    s_barrier
    s_endpgm
L_helper:
    s_setprio 3
    s_lshl_b32 s35, s67, 8
    v_lshlrev_b32 v5, 2, v0
    v_add_u32 v5, s35, v5
    v_add_u32 v5, 224, v5
    ds_write_b128 v34, v[128:131] offset:0
    ds_write_b128 v34, v[132:135] offset:1024
    v_and_b32 v6, 7, v0
    v_lshlrev_b32 v6, 1, v6
    v_add_u32 v6, s35, v6
    v_add_u32 v6, 208, v6
    ds_write_b128 v34, v[136:139] offset:2048
    v_and_b32 v7, 15, v0
    v_lshlrev_b32 v7, 4, v7
    v_add_u32 v7, s35, v7
    v_lshrrev_b32 v2, 5, v0
    v_mul_u32_u24 v2, 34816, v2
    v_add_u32 v7, v7, v2
    s_mov_b32 s40, 0x05040100
    s_mov_b32 s41, 0x07060302
    s_waitcnt lgkmcnt(0)
    s_barrier
    s_waitcnt vmcnt(3)
    v_perm_b32 v40, v18, v17, s40
    v_perm_b32 v41, v18, v17, s41
    ds_write_b32 v5, v40 offset:0
    ds_write_b32 v5, v41 offset:34816
    s_mov_b64 exec, 0xff
    ds_write_b16 v6, v16 offset:0
    ds_write_b16_d16_hi v6, v16 offset:34816
    s_mov_b64 exec, s[56:57]
    v_bfe_u32 v2, v0, 4, 1
    v_lshl_add_u32 v3, v2, 3, v7
    v_add_u32 v3, 208, v3
    v_cmp_eq_u32 vcc, 1, v2
    ds_read_b64 v[44:45], v3 offset:0
    ds_read_b64 v[46:47], v3 offset:8
    ds_read_b64 v[48:49], v3 offset:16
    v_mov_b32 v10, 208
    v_mov_b32 v14, 17584
    v_cndmask_b32 v10, v10, v14, vcc
    v_add_u32 v10, v10, v7
    v_mov_b32 v11, 4416
    v_mov_b32 v14, 21968
    v_cndmask_b32 v11, v11, v14, vcc
    v_add_u32 v11, v11, v7
    v_mov_b32 v12, 8832
    v_mov_b32 v14, 26144
    v_cndmask_b32 v12, v12, v14, vcc
    v_add_u32 v12, v12, v7
    v_mov_b32 v13, 13168
    v_mov_b32 v14, 30480
    v_cndmask_b32 v13, v13, v14, vcc
    v_add_u32 v13, v13, v7
    s_waitcnt lgkmcnt(0)
    ds_write_b128 v10, v[44:47] offset:0
    v_alignbit_b32 v52, v45, v44, 16
    v_alignbit_b32 v53, v46, v45, 16
    v_alignbit_b32 v54, v47, v46, 16
    v_alignbit_b32 v55, v48, v47, 16
    ds_write_b128 v11, v[52:55] offset:0
    v_mov_b32 v56, v45
    v_mov_b32 v57, v46
    v_mov_b32 v58, v47
    v_mov_b32 v59, v48
    ds_write_b128 v12, v[56:59] offset:0
    v_alignbit_b32 v60, v46, v45, 16
    v_alignbit_b32 v61, v47, v46, 16
    v_alignbit_b32 v62, v48, v47, 16
    v_alignbit_b32 v63, v49, v48, 16
    ds_write_b128 v13, v[60:63] offset:0
    s_waitcnt lgkmcnt(0)
    s_barrier
    s_waitcnt vmcnt(0)
    v_perm_b32 v40, v21, v20, s40
    v_perm_b32 v41, v21, v20, s41
    ds_write_b32 v5, v40 offset:1024
    ds_write_b32 v5, v41 offset:35840
    s_mov_b64 exec, 0xff
    ds_write_b16 v6, v19 offset:1024
    ds_write_b16_d16_hi v6, v19 offset:35840
    s_mov_b64 exec, s[56:57]
    ds_read_b64 v[44:45], v3 offset:1024
    ds_read_b64 v[46:47], v3 offset:1032
    ds_read_b64 v[48:49], v3 offset:1040
    s_waitcnt lgkmcnt(0)
    ds_write_b128 v10, v[44:47] offset:1024
    v_alignbit_b32 v52, v45, v44, 16
    v_alignbit_b32 v53, v46, v45, 16
    v_alignbit_b32 v54, v47, v46, 16
    v_alignbit_b32 v55, v48, v47, 16
    ds_write_b128 v11, v[52:55] offset:1024
    v_mov_b32 v56, v45
    v_mov_b32 v57, v46
    v_mov_b32 v58, v47
    v_mov_b32 v59, v48
    ds_write_b128 v12, v[56:59] offset:1024
    v_alignbit_b32 v60, v46, v45, 16
    v_alignbit_b32 v61, v47, v46, 16
    v_alignbit_b32 v62, v48, v47, 16
    v_alignbit_b32 v63, v49, v48, 16
    ds_write_b128 v13, v[60:63] offset:1024
    buffer_load_dword v23, v8, s[4:7], s78 offen
    v_lshlrev_b32 v99, 2, v0
    buffer_load_dword v98, v99, s[16:19], 0 offen sc1
    s_mov_b32 s64, 0
    s_mov_b32 s65, 1
    s_movk_i32 s43, 4096
    s_lshl_b32 s42, s67, 9
    v_lshlrev_b32 v15, 3, v0
    v_add_u32 v15, s42, v15
    v_add_u32 v4, s78, v9
    buffer_load_dword v24, v8, s[4:7], s78 offen offset:1024
    s_mov_b64 exec, 0xff
    buffer_load_dword v22, v4, s[4:7], 0 offen
    s_mov_b64 exec, s[56:57]
    s_lshl_b32 s42, s67, 9
    v_lshlrev_b32 v14, 3, v0
    v_add_u32 v14, s42, v14
    v_bfe_u32 v2, v14, 7, 2
    v_lshlrev_b32 v2, 4, v2
    v_xor_b32 v14, v2, v14
    v_add_u32 v14, 88064, v14
    v_mov_b32 v28, s72
    v_mov_b32 v29, s73
    v_lshlrev_b32 v30, 16, v28
    v_and_b32 v31, 0xffff0000, v28
    v_lshlrev_b32 v28, 16, v29
    v_and_b32 v29, 0xffff0000, v29
    v_sub_f32 v30, v30, v28
    v_sub_f32 v31, v31, v29
    s_waitcnt lgkmcnt(0)
    s_barrier
    s_waitcnt vmcnt(2)
L_poll:
    v_cmp_ne_u32 vcc, s65, v98
    s_cbranch_vccz L_pollok
    s_add_u32 s64, s64, 1
    s_cmp_gt_u32 s64, 1000000
    s_cbranch_scc1 L_pollok
    s_sleep 12
    buffer_load_dword v98, v99, s[16:19], 0 offen sc1
    s_waitcnt vmcnt(0)
    s_branch L_poll
L_pollok:
    buffer_load_dwordx2 v[90:91], v15, s[12:15], 0 offen offset:0 sc1
    buffer_load_dwordx2 v[92:93], v15, s[12:15], 0 offen offset:2048 sc1
    buffer_load_dwordx2 v[94:95], v15, s[12:15], s43 offen offset:0 sc1
    buffer_load_dwordx2 v[96:97], v15, s[12:15], s43 offen offset:2048 sc1
    buffer_load_dword v26, v8, s[4:7], s79 offen
    v_add_u32 v4, s79, v9
    buffer_load_dword v27, v8, s[4:7], s79 offen offset:1024
    s_mov_b64 exec, 0xff
    buffer_load_dword v25, v4, s[4:7], 0 offen
    s_mov_b64 exec, s[56:57]
    s_waitcnt vmcnt(7)
    v_perm_b32 v40, v24, v23, s40
    v_perm_b32 v41, v24, v23, s41
    ds_write_b32 v5, v40 offset:2048
    ds_write_b32 v5, v41 offset:36864
    s_mov_b64 exec, 0xff
    ds_write_b16 v6, v22 offset:2048
    ds_write_b16_d16_hi v6, v22 offset:36864
    s_mov_b64 exec, s[56:57]
    ds_read_b64 v[44:45], v3 offset:2048
    ds_read_b64 v[46:47], v3 offset:2056
    ds_read_b64 v[48:49], v3 offset:2064
    s_waitcnt lgkmcnt(0)
    ds_write_b128 v10, v[44:47] offset:2048
    v_alignbit_b32 v52, v45, v44, 16
    v_alignbit_b32 v53, v46, v45, 16
    v_alignbit_b32 v54, v47, v46, 16
    v_alignbit_b32 v55, v48, v47, 16
    ds_write_b128 v11, v[52:55] offset:2048
    v_mov_b32 v56, v45
    v_mov_b32 v57, v46
    v_mov_b32 v58, v47
    v_mov_b32 v59, v48
    ds_write_b128 v12, v[56:59] offset:2048
    v_alignbit_b32 v60, v46, v45, 16
    v_alignbit_b32 v61, v47, v46, 16
    v_alignbit_b32 v62, v48, v47, 16
    v_alignbit_b32 v63, v49, v48, 16
    ds_write_b128 v13, v[60:63] offset:2048
    ds_read_b64 v[64:65], v14 offset:0
    ds_read_b64 v[66:67], v14 offset:2048
    ds_read_b64 v[68:69], v14 offset:4096
    ds_read_b64 v[70:71], v14 offset:6144
    v_lshlrev_b32 v74, 16, v17
    v_and_b32 v76, 0xffff0000, v17
    v_lshlrev_b32 v75, 16, v18
    v_and_b32 v77, 0xffff0000, v18
    s_waitcnt lgkmcnt(0)
    v_sub_f32 v64, v64, v68
    v_sub_f32 v65, v65, v69
    v_sub_f32 v66, v66, v70
    v_sub_f32 v67, v67, v71
    v_fmac_f32 v68, v74, v28
    v_fmac_f32 v69, v75, v28
    v_fmac_f32 v70, v76, v29
    v_fmac_f32 v71, v77, v29
    v_fmac_f32 v64, v74, v30
    v_fmac_f32 v65, v75, v30
    v_fmac_f32 v66, v76, v31
    v_fmac_f32 v67, v77, v31
    s_waitcnt vmcnt(3)
    v_fma_f32 v64, v64, v90, v68
    v_fma_f32 v65, v65, v91, v69
    v_fma_f32 v66, v66, v90, v70
    v_fma_f32 v67, v67, v91, v71
    v_cvt_pk_bf16_f32 v80, v64, v66
    v_cvt_pk_bf16_f32 v81, v65, v67
    buffer_store_dword v80, v8, s[8:11], s76 offen
    buffer_store_dword v81, v8, s[8:11], s76 offen offset:1024
    s_waitcnt lgkmcnt(0)
    s_barrier
    ds_read_b64 v[64:65], v14 offset:8192
    ds_read_b64 v[66:67], v14 offset:10240
    ds_read_b64 v[68:69], v14 offset:12288
    ds_read_b64 v[70:71], v14 offset:14336
    v_lshlrev_b32 v74, 16, v20
    v_and_b32 v76, 0xffff0000, v20
    v_lshlrev_b32 v75, 16, v21
    v_and_b32 v77, 0xffff0000, v21
    s_waitcnt lgkmcnt(0)
    v_sub_f32 v64, v64, v68
    v_sub_f32 v65, v65, v69
    v_sub_f32 v66, v66, v70
    v_sub_f32 v67, v67, v71
    v_fmac_f32 v68, v74, v28
    v_fmac_f32 v69, v75, v28
    v_fmac_f32 v70, v76, v29
    v_fmac_f32 v71, v77, v29
    v_fmac_f32 v64, v74, v30
    v_fmac_f32 v65, v75, v30
    v_fmac_f32 v66, v76, v31
    v_fmac_f32 v67, v77, v31
    v_fma_f32 v64, v64, v92, v68
    v_fma_f32 v65, v65, v93, v69
    v_fma_f32 v66, v66, v92, v70
    v_fma_f32 v67, v67, v93, v71
    v_cvt_pk_bf16_f32 v82, v64, v66
    v_cvt_pk_bf16_f32 v83, v65, v67
    buffer_store_dword v82, v8, s[8:11], s77 offen
    buffer_store_dword v83, v8, s[8:11], s77 offen offset:1024
    s_waitcnt lgkmcnt(0)
    s_barrier
    ds_read_b64 v[64:65], v14 offset:16384
    ds_read_b64 v[66:67], v14 offset:18432
    ds_read_b64 v[68:69], v14 offset:20480
    ds_read_b64 v[70:71], v14 offset:22528
    v_lshlrev_b32 v74, 16, v23
    v_and_b32 v76, 0xffff0000, v23
    v_lshlrev_b32 v75, 16, v24
    v_and_b32 v77, 0xffff0000, v24
    s_waitcnt lgkmcnt(0)
    v_sub_f32 v64, v64, v68
    v_sub_f32 v65, v65, v69
    v_sub_f32 v66, v66, v70
    v_sub_f32 v67, v67, v71
    v_fmac_f32 v68, v74, v28
    v_fmac_f32 v69, v75, v28
    v_fmac_f32 v70, v76, v29
    v_fmac_f32 v71, v77, v29
    v_fmac_f32 v64, v74, v30
    v_fmac_f32 v65, v75, v30
    v_fmac_f32 v66, v76, v31
    v_fmac_f32 v67, v77, v31
    v_fma_f32 v64, v64, v94, v68
    v_fma_f32 v65, v65, v95, v69
    v_fma_f32 v66, v66, v94, v70
    v_fma_f32 v67, v67, v95, v71
    v_cvt_pk_bf16_f32 v84, v64, v66
    v_cvt_pk_bf16_f32 v85, v65, v67
    buffer_store_dword v84, v8, s[8:11], s78 offen
    buffer_store_dword v85, v8, s[8:11], s78 offen offset:1024
    s_waitcnt vmcnt(6)
    v_perm_b32 v40, v27, v26, s40
    v_perm_b32 v41, v27, v26, s41
    ds_write_b32 v5, v40 offset:3072
    ds_write_b32 v5, v41 offset:37888
    s_mov_b64 exec, 0xff
    ds_write_b16 v6, v25 offset:3072
    ds_write_b16_d16_hi v6, v25 offset:37888
    s_mov_b64 exec, s[56:57]
    ds_read_b64 v[44:45], v3 offset:3072
    ds_read_b64 v[46:47], v3 offset:3080
    ds_read_b64 v[48:49], v3 offset:3088
    s_waitcnt lgkmcnt(0)
    ds_write_b128 v10, v[44:47] offset:3072
    v_alignbit_b32 v52, v45, v44, 16
    v_alignbit_b32 v53, v46, v45, 16
    v_alignbit_b32 v54, v47, v46, 16
    v_alignbit_b32 v55, v48, v47, 16
    ds_write_b128 v11, v[52:55] offset:3072
    v_mov_b32 v56, v45
    v_mov_b32 v57, v46
    v_mov_b32 v58, v47
    v_mov_b32 v59, v48
    ds_write_b128 v12, v[56:59] offset:3072
    v_alignbit_b32 v60, v46, v45, 16
    v_alignbit_b32 v61, v47, v46, 16
    v_alignbit_b32 v62, v48, v47, 16
    v_alignbit_b32 v63, v49, v48, 16
    ds_write_b128 v13, v[60:63] offset:3072
    s_waitcnt lgkmcnt(0)
    s_barrier
    s_waitcnt lgkmcnt(0)
    s_barrier
    ds_read_b64 v[64:65], v14 offset:24576
    ds_read_b64 v[66:67], v14 offset:26624
    ds_read_b64 v[68:69], v14 offset:28672
    ds_read_b64 v[70:71], v14 offset:30720
    v_lshlrev_b32 v74, 16, v26
    v_and_b32 v76, 0xffff0000, v26
    v_lshlrev_b32 v75, 16, v27
    v_and_b32 v77, 0xffff0000, v27
    s_waitcnt lgkmcnt(0)
    v_sub_f32 v64, v64, v68
    v_sub_f32 v65, v65, v69
    v_sub_f32 v66, v66, v70
    v_sub_f32 v67, v67, v71
    v_fmac_f32 v68, v74, v28
    v_fmac_f32 v69, v75, v28
    v_fmac_f32 v70, v76, v29
    v_fmac_f32 v71, v77, v29
    v_fmac_f32 v64, v74, v30
    v_fmac_f32 v65, v75, v30
    v_fmac_f32 v66, v76, v31
    v_fmac_f32 v67, v77, v31
    v_fma_f32 v64, v64, v96, v68
    v_fma_f32 v65, v65, v97, v69
    v_fma_f32 v66, v66, v96, v70
    v_fma_f32 v67, v67, v97, v71
    v_cvt_pk_bf16_f32 v86, v64, v66
    v_cvt_pk_bf16_f32 v87, v65, v67
    buffer_store_dword v86, v8, s[8:11], s79 offen
    buffer_store_dword v87, v8, s[8:11], s79 offen offset:1024
L_end:
    s_endpgm
.section .rodata,"a"
.p2align 6
.amdhsa_kernel gated_mix__ssm_conv_s4d__ssm_conv_s4__prompt_kernel
  .amdhsa_next_free_vgpr 256
  .amdhsa_next_free_sgpr 102
  .amdhsa_accum_offset 256
  .amdhsa_group_segment_fixed_size 0
  .amdhsa_kernarg_size 160
  .amdhsa_user_sgpr_count 2
  .amdhsa_user_sgpr_kernarg_segment_ptr 1
  .amdhsa_system_sgpr_workgroup_id_x 1
.end_amdhsa_kernel
```
